```python
import torch

def _softmax(x, axis=-1):
    return torch.softmax(x, dim=axis)
def _gelu(x):
    return torch.nn.functional.gelu(x, approximate="tanh")
def _silu(x):
    return torch.nn.functional.silu(x)
def _sigmoid(x):
    return torch.sigmoid(x)
def _layernorm(x, axis=-1, eps=1e-5):
    m = x.mean(dim=axis, keepdim=True)
    v = x.var(dim=axis, keepdim=True, unbiased=False)
    return (x - m) / torch.sqrt(v + eps)
def _scatter_add(tgt, idx, src, axis=0):
    return tgt.clone().index_add_(axis, idx, src)
def _segment_sum(src, seg, n):
    out = torch.zeros((n,) + src.shape[1:], dtype=src.dtype)
    return out.index_add_(0, seg, src)
def _pad(x, pw):
    flat = tuple(v for pair in reversed(pw) for v in pair)
    return torch.nn.functional.pad(x, flat)

kernel_name = 'interleave_layers__sliding_block_cached__dense_activation_mish__decode'

def setup_inputs():

    _w = (lambda a: (lambda t: t.to(torch.bfloat16) if t.is_floating_point() else t)(torch.as_tensor(a)))
    def _A_setup():
        B, Sq, D = 1, 1, 512
        Hq, Hkv, Sk, Dh = 32, 8, 65536, 128
        assert Hq % Hkv == 0, (Hq, Hkv)
        return {
            "x": _w((lambda *s: torch.randn(*s, dtype=torch.bfloat16) * 0.05)(B, Sq, D)),
            "k_cache": _w((lambda *s: torch.randn(*s, dtype=torch.bfloat16) * 0.8)(B, Hkv, Sk, Dh)),
            "v_cache": _w((lambda *s: torch.randn(*s, dtype=torch.bfloat16) * 1.6)(B, Hkv, Sk, Dh)),
            "wq": _w((lambda *s: torch.randn(*s, dtype=torch.bfloat16) * 0.8)(D, Hq * Dh) * (D ** -0.5)),
            "wo": _w((lambda *s: torch.randn(*s, dtype=torch.bfloat16) * 1.6)(Hq * Dh, D) * ((Hq * Dh) ** -0.5)),
        }
    _A_in = _A_setup()

    def _B_setup():
        B, S, D, F = 1, 1, 512, 1792
        return {
            "x": _w((lambda *s: torch.randn(*s, dtype=torch.bfloat16) * 0.05)(B, S, D)),
            "w1": _w((lambda *s: torch.randn(*s, dtype=torch.bfloat16) * 1.6)(D, F) * (D ** -0.5)),
            "b1": _w((lambda *s: torch.randn(*s, dtype=torch.bfloat16) * 0.4)(F)),
            "w2": _w((lambda *s: torch.randn(*s, dtype=torch.bfloat16) * 0.2)(F, D) * (F ** -0.5)),
        }
    _B_in = _B_setup()

    return {
        "A_x": _A_in["x"],
        "A_k_cache": _A_in["k_cache"],
        "A_v_cache": _A_in["v_cache"],
        "A_wq": _A_in["wq"],
        "A_wo": _A_in["wo"],
        "B_x": _B_in["x"],
        "B_w1": _B_in["w1"],
        "B_b1": _B_in["b1"],
        "B_w2": _B_in["w2"],
    }

def reference(A_x, A_k_cache, A_v_cache, A_wq, A_wo, B_x, B_w1, B_b1, B_w2):
    def _A_ref(x, k_cache, v_cache, wq, wo):
        B, Sq, D = x.shape
        Hq, Dh = 32, 128
        Hkv, Sk = k_cache.shape[1], k_cache.shape[2]
        W = min(4096, max(256, Sk // 4))
        rep = Hq // Hkv
        q = (lambda x, *d: x.permute(*d))((x @ wq).reshape(B, Sq, Hq, Dh), 0, 2, 1, 3)
        k = (lambda x, n, axis: torch.repeat_interleave(x, n, dim=axis))(k_cache[:, :, Sk - W:, :], rep, axis=1)
        v = (lambda x, n, axis: torch.repeat_interleave(x, n, dim=axis))(v_cache[:, :, Sk - W:, :], rep, axis=1)
        scores = torch.einsum("bhqd,bhkd->bhqk", q, k) * (Dh ** -0.5)
        p = _softmax(scores, axis=-1)
        o = torch.einsum("bhqk,bhkd->bhqd", p, v)
        return (lambda x, *d: x.permute(*d))(o, 0, 2, 1, 3).reshape(B, Sq, Hq * Dh) @ wo

    def _B_ref(x, w1, b1, w2):
        h = torch.einsum("bsd,df->bsf", x, w1) + b1
        sp = torch.log1p(torch.exp(-torch.abs(h))) + torch.where(h > 0, h, torch.zeros_like(h))
        act = h * torch.tanh(sp)
        return torch.einsum("bsf,fd->bsd", act, w2)

    x = A_x
    x = x + _A_ref(_layernorm(x, axis=-1), A_k_cache, A_v_cache, A_wq, A_wo)
    x = x + _B_ref(_layernorm(x, axis=-1), B_w1, B_b1, B_w2)
    x = x + _A_ref(_layernorm(x, axis=-1), A_k_cache, A_v_cache, A_wq, A_wo)
    x = x + _B_ref(_layernorm(x, axis=-1), B_w1, B_b1, B_w2)
    return x
```

```asm
; @launch grid=(256,1,1) block=(512,1,1) lds=141824
.amdgcn_target "amdgcn-amd-amdhsa--gfx950"
.text
.globl interleave_layers__sliding_block_cached__dense_activation_mish__decode_kernel
.p2align 8
.type interleave_layers__sliding_block_cached__dense_activation_mish__decode_kernel,@function
interleave_layers__sliding_block_cached__dense_activation_mish__decode_kernel:
    s_cmp_ge_u32 s2, 256
    s_cbranch_scc1 L_exit
    s_load_dwordx16 s[8:23], s[0:1], 0
    s_load_dwordx8 s[24:31], s[0:1], 64
    s_getpc_b64 s[92:93]
    v_lshrrev_b32 v1, 6, v0
    s_and_b32 s3, s2, 7
    v_readfirstlane_b32 s5, v1
    s_lshr_b32 s4, s2, 3
    v_and_b32 v1, 63, v0
    s_and_b32 s92, s92, 0xffffff00
    v_lshlrev_b32 v4, 7, v1
    v_add_u32 v5, 0x2000, v4
    v_min_u32 v5, L_code_end-interleave_layers__sliding_block_cached__dense_activation_mish__decode_kernel-4, v5
    s_cmp_lg_u32 s5, 7
    s_cbranch_scc1 L_nocpf
    global_load_dword v239, v4, s[92:93]
    global_load_dword v239, v5, s[92:93]
L_nocpf:
    v_and_b32 v2, 15, v0
    v_lshrrev_b32 v3, 4, v1
    s_mov_b32 s57, 2097152
    s_mov_b32 s53, 0
    s_lshl_b32 s52, s3, 12
    s_lshl_b32 s56, s3, 14
    s_add_u32 s56, s56, 65536
    s_add_u32 s74, s52, 393216
    s_add_u32 s75, s74, 32768
    v_lshrrev_b32 v5, 3, v1
    v_and_b32 v6, 7, v1
    v_lshlrev_b32 v4, 13, v5
    v_lshl_add_u32 v4, v6, 7, v4
    s_lshl_b32 s48, s4, 17
    s_lshl_b32 s49, s3, 10
    s_add_u32 s48, s48, s49
    s_sub_u32 s49, s5, 1
    s_lshl_b32 s50, s49, 16
    s_add_u32 s48, s48, s50
    s_mov_b32 s50, 458752
    v_mov_b32 v7, 0
    s_mov_b32 s34, 917504
    s_mov_b32 s35, 0x00020000
    s_mov_b32 s38, 65536
    s_mov_b32 s39, 0x00020000
    s_mov_b32 s42, 65536
    s_mov_b32 s43, 0x00020000
    s_mov_b32 s46, 4194304
    s_mov_b32 s47, 0x00020000
    v_mov_b32 v210, 0
    v_lshlrev_b32 v232, 4, v1
    s_lshl_b32 s90, s3, 24
    s_lshl_b32 s51, s4, 16
    s_add_u32 s90, s90, s51
    s_add_u32 s90, s90, 15728640
    v_xor_b32 v8, v2, v3
    v_lshlrev_b32 v8, 4, v8
    v_lshl_add_u32 v8, v3, 8, v8
    v_lshlrev_b32 v5, 1, v3
    v_xor_b32 v5, v2, v5
    v_lshlrev_b32 v5, 4, v5
    v_lshl_add_u32 v5, v3, 8, v5
    s_add_u32 s77, s4, s3
    s_cmp_lt_u32 s49, 2
    s_waitcnt lgkmcnt(0)
    s_mov_b32 s44, s14
    s_mov_b32 s45, s15
    s_cbranch_scc0 L_notouch
    buffer_load_dword v240, v4, s[44:47], s48 offen
L_notouch:
    s_mov_b32 s32, s30
    s_mov_b32 s33, s31
    buffer_load_dword v241, v7, s[32:35], s50 offen sc1
    s_add_u32 s36, s10, s90
    s_addc_u32 s37, s11, 0
    s_add_u32 s40, s12, s90
    s_addc_u32 s41, s13, 0
    s_cmp_ge_u32 s4, 16
    s_cbranch_scc1 L_D_init
    s_cmp_eq_u32 s5, 4
    s_cbranch_scc1 L_A_ctl
    s_cmp_gt_u32 s5, 4
    s_cbranch_scc1 L_A_help
    s_setprio 1
    s_lshl_b32 s48, s5, 14
    s_add_u32 s51, s77, 16
L_A_kl:
    s_and_b32 s49, s77, 15
    s_and_b32 s50, s49, 3
    s_lshl_b32 s50, s50, 6
    s_lshl_b32 s49, s49, 10
    s_add_u32 s49, s49, s48
    s_mov_b32 m0, s49
    v_xor_b32 v6, s50, v8
    s_waitcnt vmcnt(5)
    buffer_load_dwordx4 v6, s[36:39], s49 offen nt lds
    s_add_u32 s77, s77, 1
    s_cmp_lt_u32 s77, s51
    s_cbranch_scc1 L_A_kl
    s_branch L_A_setup
L_A_help:
    s_sub_u32 s48, s5, 5
    s_lshl_b32 s77, s77, 2
    s_mov_b32 s51, 0
L_A_vl:
    s_add_u32 s49, s77, s48
    s_and_b32 s49, s49, 63
    s_and_b32 s50, s49, 1
    s_lshl_b32 s50, s50, 7
    s_lshl_b32 s49, s49, 10
    s_add_u32 m0, s49, 65536
    v_xor_b32 v6, s50, v5
    s_waitcnt vmcnt(9)
    buffer_load_dwordx4 v6, s[40:43], s49 offen lds
    s_add_u32 s48, s48, 3
    s_cmp_lt_u32 s48, 64
    s_cbranch_scc1 L_A_vl
    s_branch L_A_pf2
L_D_init:
    s_and_b32 s6, s4, 7
    s_lshl_b32 s7, s6, 2
    s_add_u32 s7, s7, s5
    v_lshrrev_b32 v242, 3, v1
    v_and_b32 v243, 7, v1
    s_cmp_lt_u32 s4, 24
    s_cbranch_scc1 L_D_const
    s_cmp_lg_u32 s5, 4
    s_cbranch_scc1 L_D2_e1
    v_mov_b32 v212, -1
    v_mov_b32 v213, -1
    v_mov_b32 v214, -1
    v_mov_b32 v215, -1
    s_lshl_b32 s49, s6, 11
    s_add_u32 s49, s49, s56
    s_add_u32 s50, s49, 196608
    buffer_store_dwordx4 v[212:215], v232, s[32:35], s49 offen offset:0
    buffer_store_dwordx4 v[212:215], v232, s[32:35], s49 offen offset:1024
    buffer_store_dwordx4 v[212:215], v232, s[32:35], s50 offen offset:0
    buffer_store_dwordx4 v[212:215], v232, s[32:35], s50 offen offset:1024
    s_mov_b32 s49, 196608
    v_lshrrev_b32 v224, 5, v1
    v_mul_lo_u32 v224, v224, s49
    v_and_b32 v225, 31, v1
    v_lshl_add_u32 v224, v225, 4, v224
    s_lshl_b32 s49, s6, 9
    s_add_u32 s49, s49, s52
    buffer_store_dwordx4 v[212:215], v224, s[32:35], s49 offen
    s_branch L_D2_init
L_D2_e1:
    s_cmp_lg_u32 s5, 5
    s_cbranch_scc1 L_D2_e2
    v_mov_b32 v212, -1
    v_mov_b32 v213, -1
    v_mov_b32 v214, -1
    v_mov_b32 v215, -1
    s_mov_b32 s49, 196608
    v_lshrrev_b32 v224, 3, v2
    v_mul_lo_u32 v224, v224, s49
    v_lshl_add_u32 v224, v243, 4, v224
    v_lshl_add_u32 v224, v3, 13, v224
    s_lshl_b32 s49, s3, 10
    s_lshl_b32 s50, s6, 7
    s_add_u32 s49, s49, s50
    s_add_u32 s49, s49, 32768
    s_mov_b32 exec_hi, 0
    buffer_store_dwordx4 v[212:215], v224, s[32:35], s49 offen sc1
    s_mov_b64 exec, -1
    s_branch L_D2_init
L_D2_e2:
    s_cmp_ge_u32 s5, 4
    s_cbranch_scc1 L_D2_init
    s_lshl_b32 s48, s3, 19
    s_add_u32 s36, s16, s48
    s_addc_u32 s37, s17, 0
    s_and_b32 s37, s37, 0xffff
    s_mov_b32 s38, 524288
    s_mov_b32 s39, 0x00020000
    buffer_load_dword v255, v232, s[36:39], 0 offen
L_D_const:
    v_mov_b32 v245, 0
    v_mov_b32 v244, 0
    s_mov_b32 s40, s8
    s_and_b32 s41, s9, 0xffff
    s_mov_b32 s42, 1024
    s_mov_b32 s43, 0x00020000
    v_lshrrev_b32 v49, 1, v3
    v_and_b32 v50, 1, v3
    v_lshlrev_b32 v5, 8, v49
    v_lshl_add_u32 v5, v2, 4, v5
    v_lshl_add_u32 v5, v50, 3, v5
    buffer_load_dwordx2 v[44:45], v5, s[40:43], 0 offen
    buffer_load_dwordx2 v[46:47], v5, s[40:43], 0 offen offset:512
    v_lshlrev_b32 v4, 4, v1
    v_lshrrev_b32 v51, 2, v2
    v_and_b32 v52, 3, v2
    v_lshl_add_u32 v53, v49, 7, v51
    v_lshl_add_u32 v53, v50, 2, v53
    v_lshlrev_b32 v10, 1, v2
    v_lshrrev_b32 v11, 5, v1
    v_lshlrev_b32 v11, 4, v11
    v_add_u32 v14, 132608, v4
    v_mov_b32 v12, 1.0
    v_mov_b32 v24, 0x3f803f80
    v_mov_b32 v25, 0x3f803f80
    v_mov_b32 v26, 0x3f803f80
    v_mov_b32 v27, 0x3f803f80
    v_and_b32 v54, 1, v2
    v_lshlrev_b32 v54, 4, v54
    v_mov_b32 v55, 0x3f80
    v_lshlrev_b32 v55, v54, v55
    v_lshrrev_b32 v56, 1, v2
    v_lshlrev_b32 v249, 10, v3
    v_lshl_add_u32 v249, v2, 4, v249
    v_cmp_eq_u32 vcc, 0, v56
    s_nop 1
    v_cndmask_b32 v16, 0, v55, vcc
    v_cmp_eq_u32 vcc, 1, v56
    s_nop 1
    v_cndmask_b32 v17, 0, v55, vcc
    v_cmp_eq_u32 vcc, 2, v56
    s_nop 1
    v_cndmask_b32 v18, 0, v55, vcc
    v_cmp_eq_u32 vcc, 3, v56
    s_nop 1
    v_cndmask_b32 v19, 0, v55, vcc
    v_cmp_eq_u32 vcc, 4, v56
    s_nop 1
    v_cndmask_b32 v20, 0, v55, vcc
    v_cmp_eq_u32 vcc, 5, v56
    s_nop 1
    v_cndmask_b32 v21, 0, v55, vcc
    v_cmp_eq_u32 vcc, 6, v56
    s_nop 1
    v_cndmask_b32 v22, 0, v55, vcc
    v_cmp_eq_u32 vcc, 7, v56
    s_nop 1
    v_cndmask_b32 v23, 0, v55, vcc
    s_mov_b32 s76, 0xfffefffe
    v_mov_b32 v250, 0x3b000000
    v_mov_b32 v251, 0x3727c5ac
    s_mov_b32 s79, 0xbfb8aa3b
    s_lshl_b32 s49, s7, 5
    s_lshl_b32 s84, s3, 10
    s_add_u32 s84, s84, s49
    s_lshl_b32 s50, s5, 5
    s_cmp_ge_u32 s4, 24
    s_cbranch_scc1 L_D2_comp
    s_lshl_b32 s48, s3, 10
    s_lshl_b32 s49, s6, 7
    s_add_u32 s48, s48, s49
    s_sub_u32 s51, 4194304, s48
    s_add_u32 s36, s14, s48
    s_addc_u32 s37, s15, 0
    s_and_b32 s37, s37, 0xffff
    s_mov_b32 s38, s51
    s_mov_b32 s39, 0x00020000
    v_and_b32 v245, 6, v242
    v_xor_b32 v245, v245, v243
    v_lshlrev_b32 v244, 13, v242
    v_lshl_add_u32 v244, v245, 4, v244
    s_cmp_ge_u32 s5, 4
    s_cbranch_scc1 L_D1_help
    s_setprio 1
    s_waitcnt vmcnt(0)
    s_lshl_b32 s48, s5, 14
    s_mov_b32 m0, s48
    s_lshl_b32 s49, s5, 20
    s_add_u32 s51, s49, 1048576
L_D1_wql:
    buffer_load_dwordx4 v244, s[36:39], s49 offen lds
    s_add_u32 m0, m0, 1024
    s_add_u32 s49, s49, 65536
    s_cmp_lt_u32 s49, s51
    s_cbranch_scc1 L_D1_wql
    v_bfe_u32 v54, v53, 1, 2
    v_xor_b32 v54, s5, v54
    v_lshlrev_b32 v6, 7, v53
    v_lshl_add_u32 v6, v52, 3, v6
    v_lshl_add_u32 v6, v54, 5, v6
    v_lshl_add_u32 v7, v3, 3, v51
    v_lshlrev_b32 v7, 7, v7
    v_lshl_add_u32 v7, v52, 3, v7
    s_add_u32 s50, s50, 65536
    v_add_u32 v7, s50, v7
    v_min_u32 v8, 6, v2
    v_lshlrev_b32 v8, 6, v8
    v_lshl_add_u32 v8, v3, 4, v8
    v_readfirstlane_b32 s72, v241
    s_add_u32 s84, s84, 40960
    s_mov_b32 s55, 40960
    s_lshl_b32 s49, s7, 5
    s_add_u32 s83, s52, s49
    s_mov_b32 s40, s26
    s_and_b32 s41, s27, 0xffff
    s_mov_b32 s42, 1024
    s_mov_b32 s43, 0x00020000
    s_add_u32 s72, s72, 1
    v_lshlrev_b32 v28, 16, v44
    v_and_b32 v29, 0xffff0000, v44
    v_readfirstlane_b32 s82, v28
    v_lshlrev_b32 v30, 16, v45
    v_and_b32 v31, 0xffff0000, v45
    v_lshlrev_b32 v32, 16, v46
    v_and_b32 v33, 0xffff0000, v46
    v_lshlrev_b32 v34, 16, v47
    v_and_b32 v35, 0xffff0000, v47
    v_pk_add_f32 v[36:37], v[28:29], s[82:83] op_sel_hi:[1,0] neg_lo:[0,1] neg_hi:[0,1]
    v_pk_add_f32 v[38:39], v[30:31], s[82:83] op_sel_hi:[1,0] neg_lo:[0,1] neg_hi:[0,1]
    v_pk_add_f32 v[40:41], v[32:33], s[82:83] op_sel_hi:[1,0] neg_lo:[0,1] neg_hi:[0,1]
    v_pk_add_f32 v[42:43], v[34:35], s[82:83] op_sel_hi:[1,0] neg_lo:[0,1] neg_hi:[0,1]
    v_pk_add_f32 v[50:51], v[36:37], v[38:39]
    v_pk_mul_f32 v[52:53], v[36:37], v[36:37]
    v_pk_fma_f32 v[52:53], v[38:39], v[38:39], v[52:53]
    v_pk_fma_f32 v[52:53], v[40:41], v[40:41], v[52:53]
    v_pk_add_f32 v[50:51], v[50:51], v[40:41]
    v_pk_fma_f32 v[52:53], v[42:43], v[42:43], v[52:53]
    v_pk_add_f32 v[50:51], v[50:51], v[42:43]
    v_add_f32 v52, v52, v53
    v_add_f32 v50, v50, v51
    s_nop 0
    v_add_f32_dpp v52, v52, v52 quad_perm:[1,0,3,2] row_mask:0xf bank_mask:0xf
    v_add_f32_dpp v50, v50, v50 quad_perm:[1,0,3,2] row_mask:0xf bank_mask:0xf
    s_nop 0
    v_add_f32_dpp v52, v52, v52 quad_perm:[2,3,0,1] row_mask:0xf bank_mask:0xf
    v_add_f32_dpp v50, v50, v50 quad_perm:[2,3,0,1] row_mask:0xf bank_mask:0xf
    s_nop 0
    v_add_f32_dpp v52, v52, v52 row_half_mirror row_mask:0xf bank_mask:0xf
    v_add_f32_dpp v50, v50, v50 row_half_mirror row_mask:0xf bank_mask:0xf
    s_nop 0
    v_add_f32_dpp v52, v52, v52 row_mirror row_mask:0xf bank_mask:0xf
    v_add_f32_dpp v50, v50, v50 row_mirror row_mask:0xf bank_mask:0xf
    s_nop 0
    v_add_f32_dpp v52, v52, v52 row_bcast:15 row_mask:0xa bank_mask:0xf
    v_add_f32_dpp v50, v50, v50 row_bcast:15 row_mask:0xa bank_mask:0xf
    s_nop 0
    v_add_f32_dpp v52, v52, v52 row_bcast:31 row_mask:0xc bank_mask:0xf
    v_add_f32_dpp v50, v50, v50 row_bcast:31 row_mask:0xc bank_mask:0xf
    s_nop 0
    v_readlane_b32 s81, v52, 63
    v_readlane_b32 s80, v50, 63
    s_nop 0
    v_fma_f32 v52, s81, v250, v251
    v_mul_f32 v51, s80, v250
    v_fma_f32 v52, -v51, v51, v52
    v_max_f32 v52, v251, v52
    v_rsq_f32 v52, v52
    v_add_f32 v51, s82, v51
    v_sub_f32 v36, v28, v51
    v_sub_f32 v37, v29, v51
    v_sub_f32 v38, v30, v51
    v_sub_f32 v39, v31, v51
    v_sub_f32 v40, v32, v51
    v_sub_f32 v41, v33, v51
    v_sub_f32 v42, v34, v51
    v_sub_f32 v43, v35, v51
    v_mul_f32 v36, v36, v52
    v_mul_f32 v37, v37, v52
    v_mul_f32 v38, v38, v52
    v_mul_f32 v39, v39, v52
    v_mul_f32 v40, v40, v52
    v_mul_f32 v41, v41, v52
    v_mul_f32 v42, v42, v52
    v_mul_f32 v43, v43, v52
    v_cvt_pk_bf16_f32 v64, v36, v37
    v_cvt_pk_bf16_f32 v65, v38, v39
    v_cvt_pk_bf16_f32 v66, v40, v41
    v_cvt_pk_bf16_f32 v67, v42, v43
    v_mov_b32 v48, 0
    v_mov_b32 v77, s72
    s_lshl_b32 s49, s7, 6
    v_lshl_add_u32 v55, v2, 2, s49
    s_waitcnt vmcnt(0)
    s_barrier
    ds_read_b64_tr_b16 v[96:97], v6 offset:0
    ds_read_b64_tr_b16 v[98:99], v6 offset:32768
    ds_read_b64_tr_b16 v[100:101], v6 offset:1024
    ds_read_b64_tr_b16 v[102:103], v6 offset:33792
    ds_read_b64_tr_b16 v[104:105], v6 offset:2048
    ds_read_b64_tr_b16 v[106:107], v6 offset:34816
    ds_read_b64_tr_b16 v[108:109], v6 offset:3072
    ds_read_b64_tr_b16 v[110:111], v6 offset:35840
    ds_read_b64_tr_b16 v[112:113], v6 offset:4096
    ds_read_b64_tr_b16 v[114:115], v6 offset:36864
    ds_read_b64_tr_b16 v[116:117], v6 offset:5120
    ds_read_b64_tr_b16 v[118:119], v6 offset:37888
    ds_read_b64_tr_b16 v[120:121], v6 offset:6144
    ds_read_b64_tr_b16 v[122:123], v6 offset:38912
    ds_read_b64_tr_b16 v[124:125], v6 offset:7168
    ds_read_b64_tr_b16 v[126:127], v6 offset:39936
    ds_read_b64_tr_b16 v[128:129], v6 offset:8192
    ds_read_b64_tr_b16 v[130:131], v6 offset:40960
    ds_read_b64_tr_b16 v[132:133], v6 offset:9216
    ds_read_b64_tr_b16 v[134:135], v6 offset:41984
    ds_read_b64_tr_b16 v[136:137], v6 offset:10240
    ds_read_b64_tr_b16 v[138:139], v6 offset:43008
    ds_read_b64_tr_b16 v[140:141], v6 offset:11264
    ds_read_b64_tr_b16 v[142:143], v6 offset:44032
    ds_read_b64_tr_b16 v[144:145], v6 offset:12288
    ds_read_b64_tr_b16 v[146:147], v6 offset:45056
    ds_read_b64_tr_b16 v[148:149], v6 offset:13312
    ds_read_b64_tr_b16 v[150:151], v6 offset:46080
    ds_read_b64_tr_b16 v[152:153], v6 offset:14336
    ds_read_b64_tr_b16 v[154:155], v6 offset:47104
    ds_read_b64_tr_b16 v[156:157], v6 offset:15360
    ds_read_b64_tr_b16 v[158:159], v6 offset:48128
    s_waitcnt lgkmcnt(15)
    v_mfma_f32_16x16x32_bf16 v[160:163], v[64:67], v[96:99], 0
    s_nop 3
    v_mfma_f32_16x16x32_bf16 v[164:167], v[64:67], v[100:103], 0
    s_nop 3
    v_mfma_f32_16x16x32_bf16 v[168:171], v[64:67], v[104:107], 0
    s_nop 2
    v_add_f32_dpp v48, v160, v165 quad_perm:[0,1,2,3] row_mask:0x1 bank_mask:0xf
    v_mfma_f32_16x16x32_bf16 v[172:175], v[64:67], v[108:111], 0
    s_nop 2
    v_add_f32_dpp v48, v170, v48 quad_perm:[0,1,2,3] row_mask:0x1 bank_mask:0xf
    v_mfma_f32_16x16x32_bf16 v[176:179], v[64:67], v[112:115], 0
    s_nop 2
    v_add_f32_dpp v48, v175, v48 quad_perm:[0,1,2,3] row_mask:0x1 bank_mask:0xf
    v_mfma_f32_16x16x32_bf16 v[180:183], v[64:67], v[116:119], 0
    s_nop 3
    v_mfma_f32_16x16x32_bf16 v[184:187], v[64:67], v[120:123], 0
    s_nop 2
    v_add_f32_dpp v48, v176, v181 quad_perm:[0,1,2,3] row_mask:0x2 bank_mask:0xf
    v_mfma_f32_16x16x32_bf16 v[188:191], v[64:67], v[124:127], 0
    s_nop 2
    v_add_f32_dpp v48, v186, v48 quad_perm:[0,1,2,3] row_mask:0x2 bank_mask:0xf
    s_waitcnt lgkmcnt(14)
    v_mfma_f32_16x16x32_bf16 v[160:163], v[64:67], v[128:131], 0
    s_nop 1
    v_add_f32_dpp v48, v191, v48 quad_perm:[0,1,2,3] row_mask:0x2 bank_mask:0xf
    s_nop 0
    s_waitcnt lgkmcnt(12)
    v_mfma_f32_16x16x32_bf16 v[164:167], v[64:67], v[132:135], 0
    s_nop 3
    s_waitcnt lgkmcnt(10)
    v_mfma_f32_16x16x32_bf16 v[168:171], v[64:67], v[136:139], 0
    s_nop 1
    v_add_f32_dpp v48, v160, v165 quad_perm:[0,1,2,3] row_mask:0x4 bank_mask:0xf
    s_nop 0
    s_waitcnt lgkmcnt(8)
    v_mfma_f32_16x16x32_bf16 v[172:175], v[64:67], v[140:143], 0
    s_nop 1
    v_add_f32_dpp v48, v170, v48 quad_perm:[0,1,2,3] row_mask:0x4 bank_mask:0xf
    s_nop 0
    s_waitcnt lgkmcnt(6)
    v_mfma_f32_16x16x32_bf16 v[176:179], v[64:67], v[144:147], 0
    s_nop 1
    v_add_f32_dpp v48, v175, v48 quad_perm:[0,1,2,3] row_mask:0x4 bank_mask:0xf
    s_nop 0
    s_waitcnt lgkmcnt(4)
    v_mfma_f32_16x16x32_bf16 v[180:183], v[64:67], v[148:151], 0
    s_nop 3
    s_waitcnt lgkmcnt(2)
    v_mfma_f32_16x16x32_bf16 v[184:187], v[64:67], v[152:155], 0
    s_nop 1
    v_add_f32_dpp v48, v176, v181 quad_perm:[0,1,2,3] row_mask:0x8 bank_mask:0xf
    s_nop 0
    s_waitcnt lgkmcnt(0)
    v_mfma_f32_16x16x32_bf16 v[188:191], v[64:67], v[156:159], 0
    s_nop 1
    v_add_f32_dpp v48, v186, v48 quad_perm:[0,1,2,3] row_mask:0x8 bank_mask:0xf
    s_nop 4
    v_add_f32_dpp v48, v191, v48 quad_perm:[0,1,2,3] row_mask:0x8 bank_mask:0xf
    v_mov_b32 v54, v48
    s_nop 1
    v_permlane16_swap_b32 v48, v54
    v_add_f32 v48, v48, v54
    v_mov_b32 v54, v48
    s_nop 1
    v_permlane32_swap_b32 v48, v54
    v_add_f32 v48, v48, v54
    s_nop 1
    v_mov_b32_dpp v54, v48 quad_perm:[1,1,3,3] row_mask:0xf bank_mask:0xf
    v_cvt_pk_bf16_f32 v76, v48, v54
    s_mov_b64 exec, 0x5555
    buffer_store_dwordx2 v[76:77], v55, s[32:35], s74 offen
    s_mov_b64 exec, -1
    v_mov_b32 v56, 0
    buffer_load_dword v84, v56, s[40:43], 0 offen
    v_mfma_f32_16x16x32_bf16 v[232:235], v[24:27], v[96:99], 0
    v_mfma_f32_16x16x32_bf16 v[232:235], v[24:27], v[100:103], v[232:235]
    v_mfma_f32_16x16x32_bf16 v[232:235], v[24:27], v[104:107], v[232:235]
    v_mfma_f32_16x16x32_bf16 v[232:235], v[24:27], v[108:111], v[232:235]
    v_mfma_f32_16x16x32_bf16 v[232:235], v[24:27], v[112:115], v[232:235]
    v_mfma_f32_16x16x32_bf16 v[232:235], v[24:27], v[116:119], v[232:235]
    v_mfma_f32_16x16x32_bf16 v[232:235], v[24:27], v[120:123], v[232:235]
    v_mfma_f32_16x16x32_bf16 v[232:235], v[24:27], v[124:127], v[232:235]
    v_mfma_f32_16x16x32_bf16 v[232:235], v[24:27], v[128:131], v[232:235]
    v_mfma_f32_16x16x32_bf16 v[232:235], v[24:27], v[132:135], v[232:235]
    v_mfma_f32_16x16x32_bf16 v[232:235], v[24:27], v[136:139], v[232:235]
    v_mfma_f32_16x16x32_bf16 v[232:235], v[24:27], v[140:143], v[232:235]
    v_mfma_f32_16x16x32_bf16 v[232:235], v[24:27], v[144:147], v[232:235]
    v_mfma_f32_16x16x32_bf16 v[232:235], v[24:27], v[148:151], v[232:235]
    v_mfma_f32_16x16x32_bf16 v[232:235], v[24:27], v[152:155], v[232:235]
    v_mfma_f32_16x16x32_bf16 v[232:235], v[24:27], v[156:159], v[232:235]
    s_nop 7
    v_mov_b32 v0, v232
    s_barrier
    v_mov_b32 v49, 141312
    ds_read_b32 v50, v49
    s_waitcnt lgkmcnt(0)
    v_readfirstlane_b32 s92, v50
    s_cmp_eq_u32 s7, 0
    s_cselect_b32 s49, -1, 0
    s_nop 2
    s_cmp_eq_u32 s92, 1
    s_cselect_b32 s60, 0xffff, 0
    s_cselect_b32 s61, 0, 0
    s_cselect_b32 s62, 0, 0xffff
    s_cselect_b32 s63, 0, 0
    s_cselect_b32 s64, s49, 0
    s_cselect_b32 s65, s49, 0
    s_cselect_b32 s66, 0, s49
    s_cselect_b32 s67, 0, s49
    s_cselect_b32 s49, 0, 524288
    s_add_u32 s52, s52, s49
    s_add_u32 s56, s56, s49
    s_add_u32 s83, s83, s49
    s_mov_b32 s49, 0x5555
    s_cmp_eq_u32 s92, 1
    s_cselect_b32 exec_lo, 0, s49
    s_mov_b32 exec_hi, 0
    buffer_store_dwordx2 v[76:77], v55, s[32:35], s75 offen sc1
    s_mov_b64 exec, -1
    s_barrier
    ds_read_b64_tr_b16 v[192:193], v7 offset:0
    ds_read_b64_tr_b16 v[194:195], v7 offset:512
    ds_read_b64_tr_b16 v[196:197], v7 offset:4096
    ds_read_b64_tr_b16 v[198:199], v7 offset:4608
    ds_read_b64_tr_b16 v[200:201], v7 offset:8192
    ds_read_b64_tr_b16 v[202:203], v7 offset:8704
    ds_read_b64_tr_b16 v[204:205], v7 offset:12288
    ds_read_b64_tr_b16 v[206:207], v7 offset:12800
    ds_read_b64_tr_b16 v[208:209], v7 offset:16384
    ds_read_b64_tr_b16 v[210:211], v7 offset:16896
    ds_read_b64_tr_b16 v[212:213], v7 offset:20480
    ds_read_b64_tr_b16 v[214:215], v7 offset:20992
    ds_read_b64_tr_b16 v[216:217], v7 offset:24576
    ds_read_b64_tr_b16 v[218:219], v7 offset:25088
    s_waitcnt lgkmcnt(0)
L_D1_act:
    v_mov_b32 v224, -1
    v_mov_b32 v225, -1
    v_mov_b32 v226, -1
    v_mov_b32 v227, -1
    buffer_load_dwordx4 v[232:235], v4, s[32:35], s52 offen offset:2048 sc1
    v_mov_b32 v48, 0
L_ga_poll:
    buffer_load_dwordx4 v[224:227], v8, s[32:35], s52 offen offset:3584 sc1
    s_waitcnt vmcnt(2)
    v_pk_max_u16 v49, v224, v225
    v_pk_max_u16 v50, v226, v227
    v_pk_max_u16 v49, v49, v50
    v_pk_max_u16 v49, v49, v49 op_sel:[0,1] op_sel_hi:[1,0]
    v_cmp_eq_u32 vcc, -1, v49
    s_cbranch_vccz L_ga_ok
    s_sub_u32 s57, s57, 1
    s_cbranch_scc1 L_exit
    s_branch L_ga_poll
L_ga_ok:
    buffer_load_dwordx4 v[232:235], v4, s[32:35], s52 offen offset:2048 sc1
    v_mfma_f32_16x16x32_bf16 v[160:163], v[224:227], v[192:195], 0
    s_nop 3
    v_mfma_f32_16x16x32_bf16 v[164:167], v[224:227], v[196:199], 0
    s_nop 3
    v_mfma_f32_16x16x32_bf16 v[168:171], v[224:227], v[200:203], 0
    s_nop 2
    v_add_f32_dpp v48, v160, v165 quad_perm:[0,1,2,3] row_mask:0x1 bank_mask:0xf
    v_mfma_f32_16x16x32_bf16 v[172:175], v[224:227], v[204:207], 0
    s_nop 2
    v_add_f32_dpp v48, v170, v48 quad_perm:[0,1,2,3] row_mask:0x1 bank_mask:0xf
    v_mfma_f32_16x16x32_bf16 v[176:179], v[224:227], v[208:211], 0
    s_nop 2
    v_add_f32_dpp v48, v175, v48 quad_perm:[0,1,2,3] row_mask:0x1 bank_mask:0xf
    v_mfma_f32_16x16x32_bf16 v[180:183], v[224:227], v[212:215], 0
    s_nop 3
    v_mfma_f32_16x16x32_bf16 v[184:187], v[224:227], v[216:219], 0
    s_nop 2
    v_add_f32_dpp v48, v176, v181 quad_perm:[0,1,2,3] row_mask:0x2 bank_mask:0xf
    s_nop 3
    v_add_f32_dpp v48, v186, v48 quad_perm:[0,1,2,3] row_mask:0x2 bank_mask:0xf
    v_mov_b32 v54, v48
    s_nop 1
    v_permlane16_swap_b32 v48, v54
    v_add_f32 v48, v48, v54
    v_mov_b32 v54, v48
    s_nop 1
    v_permlane32_swap_b32 v48, v54
    v_add_f32 v48, v48, v54
    s_nop 1
    v_mov_b32_dpp v54, v48 quad_perm:[1,1,3,3] row_mask:0xf bank_mask:0xf
    s_mov_b64 exec, 0x5555
    v_cvt_pk_bf16_f32 v48, v48, v54
    v_pk_min_u16 v48, v48, s76
    buffer_store_dword v48, v10, s[32:35], s84 offen sc1
    s_mov_b64 exec, -1
    s_add_u32 s53, s53, 1
    s_cmp_lt_u32 s53, 2
    s_cbranch_scc1 L_D1_z
    s_cmp_lg_u32 s2, 128
    s_cbranch_scc1 L_D1_end
    s_cmp_lg_u32 s5, 0
    s_cbranch_scc1 L_D1_end
L_D1_z:
    v_mov_b32 v48, 0
    s_cmp_lg_u32 s5, 0
    s_cbranch_scc1 L_gz_other
    s_waitcnt vmcnt(1)
    v_pk_max_u16 v49, v232, v233
    v_pk_max_u16 v50, v234, v235
    v_pk_max_u16 v49, v49, v50
    v_pk_max_u16 v49, v49, v49 op_sel:[0,1] op_sel_hi:[1,0]
    v_cmp_eq_u32 vcc, -1, v49
    s_cbranch_vccz L_gx1_have
L_gx1_poll:
    buffer_load_dwordx4 v[232:235], v4, s[32:35], s52 offen offset:2048 sc1
    s_waitcnt vmcnt(0)
    v_pk_max_u16 v49, v232, v233
    v_pk_max_u16 v50, v234, v235
    v_pk_max_u16 v49, v49, v50
    v_pk_max_u16 v49, v49, v49 op_sel:[0,1] op_sel_hi:[1,0]
    v_cmp_eq_u32 vcc, -1, v49
    s_cbranch_vccz L_gx1_ok
    s_sub_u32 s57, s57, 1
    s_cbranch_scc1 L_exit
    s_branch L_gx1_poll
L_gx1_ok:
L_gx1_have:
    v_lshlrev_b32 v28, 16, v232
    v_and_b32 v29, 0xffff0000, v232
    v_lshlrev_b32 v30, 16, v233
    v_and_b32 v31, 0xffff0000, v233
    v_lshlrev_b32 v32, 16, v234
    v_and_b32 v33, 0xffff0000, v234
    v_lshlrev_b32 v34, 16, v235
    v_and_b32 v35, 0xffff0000, v235
    s_add_u32 s48, s55, 4096
    s_waitcnt vmcnt(0)
    s_branch L_gz_again
L_gz_nan:
    s_sub_u32 s57, s57, 1
    s_cbranch_scc1 L_exit
    s_and_b32 s49, s57, 15
    s_cbranch_scc0 L_gz_retry
L_gz_again:
    buffer_load_dwordx4 v[64:67], v249, s[32:35], s55 offen offset:0 sc1
    buffer_load_dwordx4 v[68:71], v249, s[32:35], s55 offen offset:256 sc1
    buffer_load_dwordx4 v[72:75], v249, s[32:35], s55 offen offset:512 sc1
    buffer_load_dwordx4 v[76:79], v249, s[32:35], s55 offen offset:768 sc1
    buffer_load_dwordx4 v[80:83], v249, s[32:35], s48 offen offset:0 sc1
    buffer_load_dwordx4 v[84:87], v249, s[32:35], s48 offen offset:256 sc1
    buffer_load_dwordx4 v[88:91], v249, s[32:35], s48 offen offset:512 sc1
    buffer_load_dwordx4 v[92:95], v249, s[32:35], s48 offen offset:768 sc1
    s_waitcnt vmcnt(7)
    v_mfma_f32_16x16x32_bf16 v[36:39], v[16:19], v[64:67], v[28:31]
    s_waitcnt vmcnt(6)
    v_mfma_f32_16x16x32_bf16 v[36:39], v[20:23], v[68:71], v[36:39]
    s_waitcnt vmcnt(5)
    v_mfma_f32_16x16x32_bf16 v[40:43], v[16:19], v[72:75], v[32:35]
    s_waitcnt vmcnt(4)
    v_mfma_f32_16x16x32_bf16 v[40:43], v[20:23], v[76:79], v[40:43]
    s_waitcnt vmcnt(3)
    v_mfma_f32_16x16x32_bf16 v[36:39], v[16:19], v[80:83], v[36:39]
    s_waitcnt vmcnt(2)
    v_mfma_f32_16x16x32_bf16 v[36:39], v[20:23], v[84:87], v[36:39]
    s_waitcnt vmcnt(1)
    v_mfma_f32_16x16x32_bf16 v[40:43], v[16:19], v[88:91], v[40:43]
    s_waitcnt vmcnt(0)
    v_mfma_f32_16x16x32_bf16 v[40:43], v[20:23], v[92:95], v[40:43]
    s_nop 6
    v_cmp_u_f32 vcc, v36, v36
    v_cmp_u_f32 s[80:81], v40, v40
    v_cvt_pk_bf16_f32 v44, v36, v37
    v_cvt_pk_bf16_f32 v45, v38, v39
    v_cvt_pk_bf16_f32 v46, v40, v41
    v_cvt_pk_bf16_f32 v47, v42, v43
    s_or_b64 vcc, vcc, s[80:81]
    s_cbranch_vccnz L_gz_nan
L_gz_ok:
    s_cmp_eq_u32 s53, 2
    s_cbranch_scc1 L_D1_out
    ds_write_b128 v14, v[44:47]
    s_waitcnt lgkmcnt(0)
    s_barrier
    s_branch L_gz_join
L_gz_other:
    s_waitcnt vmcnt(0)
    s_barrier
    ds_read_b128 v[44:47], v14
    s_waitcnt lgkmcnt(0)
L_gz_join:
    v_mfma_f32_16x16x32_bf16 v[160:163], v[44:47], v[96:99], 0
    v_lshlrev_b32 v28, 16, v44
    v_and_b32 v29, 0xffff0000, v44
    v_readfirstlane_b32 s82, v28
    v_mfma_f32_16x16x32_bf16 v[164:167], v[44:47], v[100:103], 0
    v_lshlrev_b32 v30, 16, v45
    v_and_b32 v31, 0xffff0000, v45
    v_lshlrev_b32 v32, 16, v46
    v_mfma_f32_16x16x32_bf16 v[168:171], v[44:47], v[104:107], 0
    v_and_b32 v33, 0xffff0000, v46
    v_lshlrev_b32 v34, 16, v47
    v_and_b32 v35, 0xffff0000, v47
    v_mfma_f32_16x16x32_bf16 v[172:175], v[44:47], v[108:111], 0
    v_add_f32_dpp v48, v160, v165 quad_perm:[0,1,2,3] row_mask:0x1 bank_mask:0xf
    v_pk_add_f32 v[36:37], v[28:29], s[82:83] op_sel_hi:[1,0] neg_lo:[0,1] neg_hi:[0,1]
    v_pk_add_f32 v[38:39], v[30:31], s[82:83] op_sel_hi:[1,0] neg_lo:[0,1] neg_hi:[0,1]
    v_mfma_f32_16x16x32_bf16 v[176:179], v[44:47], v[112:115], 0
    v_add_f32_dpp v48, v170, v48 quad_perm:[0,1,2,3] row_mask:0x1 bank_mask:0xf
    v_pk_add_f32 v[40:41], v[32:33], s[82:83] op_sel_hi:[1,0] neg_lo:[0,1] neg_hi:[0,1]
    v_pk_add_f32 v[42:43], v[34:35], s[82:83] op_sel_hi:[1,0] neg_lo:[0,1] neg_hi:[0,1]
    v_mfma_f32_16x16x32_bf16 v[180:183], v[44:47], v[116:119], 0
    v_add_f32_dpp v48, v175, v48 quad_perm:[0,1,2,3] row_mask:0x1 bank_mask:0xf
    v_pk_add_f32 v[50:51], v[36:37], v[38:39]
    v_pk_mul_f32 v[52:53], v[36:37], v[36:37]
    v_mfma_f32_16x16x32_bf16 v[184:187], v[44:47], v[120:123], 0
    v_pk_fma_f32 v[52:53], v[38:39], v[38:39], v[52:53]
    v_pk_fma_f32 v[52:53], v[40:41], v[40:41], v[52:53]
    v_pk_add_f32 v[50:51], v[50:51], v[40:41]
    v_mfma_f32_16x16x32_bf16 v[188:191], v[44:47], v[124:127], 0
    v_add_f32_dpp v48, v176, v181 quad_perm:[0,1,2,3] row_mask:0x2 bank_mask:0xf
    v_pk_fma_f32 v[52:53], v[42:43], v[42:43], v[52:53]
    v_pk_add_f32 v[50:51], v[50:51], v[42:43]
    v_mfma_f32_16x16x32_bf16 v[160:163], v[44:47], v[128:131], 0
    v_add_f32_dpp v48, v186, v48 quad_perm:[0,1,2,3] row_mask:0x2 bank_mask:0xf
    v_add_f32 v52, v52, v53
    v_add_f32 v50, v50, v51
    v_mfma_f32_16x16x32_bf16 v[164:167], v[44:47], v[132:135], 0
    v_add_f32_dpp v48, v191, v48 quad_perm:[0,1,2,3] row_mask:0x2 bank_mask:0xf
    s_nop 0
    v_add_f32_dpp v52, v52, v52 quad_perm:[1,0,3,2] row_mask:0xf bank_mask:0xf
    v_mfma_f32_16x16x32_bf16 v[168:171], v[44:47], v[136:139], 0
    v_add_f32_dpp v50, v50, v50 quad_perm:[1,0,3,2] row_mask:0xf bank_mask:0xf
    s_nop 0
    v_add_f32_dpp v52, v52, v52 quad_perm:[2,3,0,1] row_mask:0xf bank_mask:0xf
    v_mfma_f32_16x16x32_bf16 v[172:175], v[44:47], v[140:143], 0
    v_add_f32_dpp v48, v160, v165 quad_perm:[0,1,2,3] row_mask:0x4 bank_mask:0xf
    v_add_f32_dpp v50, v50, v50 quad_perm:[2,3,0,1] row_mask:0xf bank_mask:0xf
    s_nop 0
    v_mfma_f32_16x16x32_bf16 v[176:179], v[44:47], v[144:147], 0
    v_add_f32_dpp v48, v170, v48 quad_perm:[0,1,2,3] row_mask:0x4 bank_mask:0xf
    v_add_f32_dpp v52, v52, v52 row_half_mirror row_mask:0xf bank_mask:0xf
    v_add_f32_dpp v50, v50, v50 row_half_mirror row_mask:0xf bank_mask:0xf
    v_mfma_f32_16x16x32_bf16 v[180:183], v[44:47], v[148:151], 0
    v_add_f32_dpp v48, v175, v48 quad_perm:[0,1,2,3] row_mask:0x4 bank_mask:0xf
    s_nop 0
    v_add_f32_dpp v52, v52, v52 row_mirror row_mask:0xf bank_mask:0xf
    v_mfma_f32_16x16x32_bf16 v[184:187], v[44:47], v[152:155], 0
    v_add_f32_dpp v50, v50, v50 row_mirror row_mask:0xf bank_mask:0xf
    s_nop 0
    v_add_f32_dpp v52, v52, v52 row_bcast:15 row_mask:0xa bank_mask:0xf
    v_mfma_f32_16x16x32_bf16 v[188:191], v[44:47], v[156:159], 0
    v_add_f32_dpp v48, v176, v181 quad_perm:[0,1,2,3] row_mask:0x8 bank_mask:0xf
    v_add_f32_dpp v50, v50, v50 row_bcast:15 row_mask:0xa bank_mask:0xf
    s_nop 0
    v_add_f32_dpp v52, v52, v52 row_bcast:31 row_mask:0xc bank_mask:0xf
    v_add_f32_dpp v48, v186, v48 quad_perm:[0,1,2,3] row_mask:0x8 bank_mask:0xf
    v_add_f32_dpp v50, v50, v50 row_bcast:31 row_mask:0xc bank_mask:0xf
    s_nop 0
    v_readlane_b32 s81, v52, 63
    v_add_f32_dpp v48, v191, v48 quad_perm:[0,1,2,3] row_mask:0x8 bank_mask:0xf
    v_readlane_b32 s80, v50, 63
    s_nop 0
    v_fma_f32 v52, s81, v250, v251
    v_mul_f32 v51, s80, v250
    v_fma_f32 v52, -v51, v51, v52
    v_max_f32 v52, v251, v52
    v_rsq_f32 v52, v52
    v_add_f32 v51, s82, v51
    s_add_u32 s52, s52, 196608
    s_add_u32 s83, s83, 196608
    s_add_u32 s84, s84, 196608
    s_add_u32 s55, s55, 196608
    v_mov_b32 v54, v48
    s_nop 1
    v_permlane16_swap_b32 v48, v54
    v_add_f32 v48, v48, v54
    v_mov_b32 v54, v48
    s_nop 1
    v_permlane32_swap_b32 v48, v54
    v_add_f32 v48, v48, v54
    v_fma_f32 v48, -v51, v0, v48
    v_mul_f32 v48, v48, v52
    v_cvt_pk_bf16_f32 v48, v48, v48
    v_min_u32 v48, -2, v48
    s_mov_b64 exec, s[60:61]
    buffer_store_short v48, v10, s[32:35], s83 offen
    s_mov_b64 exec, s[62:63]
    buffer_store_short v48, v10, s[32:35], s83 offen sc1
    s_mov_b64 exec, -1
    v_pk_min_u16 v56, v44, s76
    v_pk_min_u16 v57, v45, s76
    v_pk_min_u16 v58, v46, s76
    v_pk_min_u16 v59, v47, s76
    s_mov_b64 exec, s[64:65]
    buffer_store_dwordx4 v[56:59], v4, s[32:35], s52 offen offset:1024
    s_mov_b64 exec, s[66:67]
    buffer_store_dwordx4 v[56:59], v4, s[32:35], s52 offen offset:1024 sc1
    s_mov_b64 exec, -1
    s_branch L_D1_act
L_D1_out:
    buffer_store_dwordx2 v[44:45], v5, s[40:43], 0 offen
    buffer_store_dwordx2 v[46:47], v5, s[40:43], 0 offen offset:512
    v_mov_b32 v49, s72
    v_mov_b32 v50, 458752
    s_mov_b64 exec, 1
    buffer_store_dword v49, v50, s[32:35], 0 offen
L_D1_end:
    s_endpgm
L_A_pf2:
    s_mul_i32 s49, s3, 229376
    s_mul_i32 s50, s4, 14336
    s_add_u32 s49, s49, s50
    s_cmp_eq_u32 s5, 6
    s_cselect_b32 s51, 0, 0
    s_add_u32 s44, s24, s49
    s_addc_u32 s45, s25, 0
    s_and_b32 s45, s45, 0xffff
    s_mov_b32 s46, s51
    s_mov_b32 s47, 0x00020000
    s_mov_b32 s49, 0
    s_mov_b32 s50, 8192
    v_lshlrev_b32 v6, 7, v1
    buffer_load_dword v240, v6, s[44:47], s49 offen
    buffer_load_dword v240, v6, s[44:47], s50 offen
    s_barrier
    s_waitcnt vmcnt(2)
    s_barrier
    s_endpgm
L_A_ctl:
    s_waitcnt vmcnt(0)
    v_readfirstlane_b32 s72, v241
    s_nop 3
    s_add_u32 s72, s72, 1
    s_getreg_b32 s73, hwreg(HW_REG_XCC_ID, 0, 4)
    v_mov_b32 v209, s72
    s_lshl_b32 s51, s4, 3
    v_mov_b32 v208, s73
    v_mov_b32 v210, s51
    s_mov_b64 exec, 1
    buffer_store_dwordx2 v[208:209], v210, s[32:35], s74 offen offset:2048
    s_mov_b64 exec, -1
    v_lshrrev_b32 v229, 5, v1
    v_lshlrev_b32 v229, 6, v229
    v_lshl_add_u32 v229, v1, 3, v229
    v_add_u32 v229, 131072, v229
    s_sub_u32 s81, s57, 160
    v_and_b32 v211, 31, v1
    v_lshlrev_b32 v211, 3, v211
    s_not_b32 s49, s72
    v_mov_b32 v213, s49
    v_mov_b32 v215, s49
    v_mov_b32 v217, s49
    v_mov_b32 v219, s49
    v_mov_b32 v221, s49
L_aq0_poll:
    buffer_load_dwordx4 v[212:215], v232, s[32:35], s74 offen sc1
    buffer_load_dwordx4 v[216:219], v232, s[32:35], s74 offen offset:1024 sc1
    buffer_load_dwordx2 v[220:221], v211, s[32:35], s74 offen offset:2048 sc1
    s_waitcnt vmcnt(18)
    v_xor_b32 v224, s72, v213
    v_xor_b32 v225, s72, v215
    v_xor_b32 v226, s72, v217
    v_xor_b32 v227, s72, v219
    v_or3_b32 v224, v224, v225, v226
    v_or_b32 v224, v224, v227
    v_cmp_ne_u32 vcc, 0, v224
    s_cbranch_vccz L_aq0_seen
    s_sleep 3
    s_cmp_gt_u32 s57, s81
    s_cbranch_scc0 L_aq0_b
    s_sub_u32 s57, s57, 1
    s_cbranch_scc1 L_exit
    s_branch L_aq0_poll
L_aq0_seen:
    s_nop 15
L_aq0_ok:
    ds_write2_b32 v229, v212, v214 offset0:0 offset1:1
    ds_write2_b32 v229, v216, v218 offset0:160 offset1:161
    s_waitcnt lgkmcnt(0)
    s_barrier
    s_sub_u32 s81, s57, 160
L_ax_poll:
    buffer_load_dwordx2 v[220:221], v211, s[32:35], s74 offen offset:2048 sc1
    s_waitcnt vmcnt(24)
    v_cmp_ne_u32 vcc, s72, v221
    s_cbranch_vccz L_ax_seen
    s_sleep 3
    s_cmp_gt_u32 s57, s81
    s_cbranch_scc0 L_ax_b
    s_sub_u32 s57, s57, 1
    s_cbranch_scc1 L_exit
    s_branch L_ax_poll
L_ax_seen:
    s_nop 15
L_ax_ok:
    v_cmp_ne_u32 vcc, s73, v220
    s_nop 3
    s_cmp_eq_u64 vcc, 0
    s_cselect_b32 s92, 1, 0
    s_cbranch_scc0 L_ax_slow
L_ax_done:
    v_mov_b32 v226, 141312
    v_mov_b32 v227, s92
    ds_write_b32 v226, v227
    s_waitcnt lgkmcnt(0)
    s_cmp_eq_u32 s92, 1
    s_cselect_b32 s50, 0, 524288
    s_add_u32 s91, s52, s50
    s_add_u32 s91, s91, 196608
    v_lshl_add_u32 v226, v3, 6, v232
    v_add_u32 v226, 131072, v226
    s_barrier
    s_waitcnt vmcnt(0)
    v_mov_b32 v212, -1
    v_mov_b32 v213, -1
    v_mov_b32 v214, -1
    v_mov_b32 v215, -1
L_aq_poll:
    buffer_load_dwordx4 v[212:215], v232, s[32:35], s91 offen offset:0 sc1
    s_waitcnt vmcnt(2)
    v_pk_max_u16 v224, v212, v213
    v_pk_max_u16 v225, v214, v215
    v_pk_max_u16 v224, v224, v225
    v_pk_max_u16 v224, v224, v224 op_sel:[0,1] op_sel_hi:[1,0]
    v_cmp_eq_u32 vcc, -1, v224
    s_cbranch_vccz L_aq_ok
    s_sub_u32 s57, s57, 1
    s_cbranch_scc1 L_exit
    s_branch L_aq_poll
L_aq_ok:
    ds_write_b128 v226, v[212:215]
    s_waitcnt lgkmcnt(0)
    s_barrier
    s_endpgm
L_A_setup:
    s_setprio 1
    v_xor_b32 v4, v2, v3
    v_lshlrev_b32 v4, 4, v4
    v_lshl_add_u32 v4, v2, 8, v4
    v_add_u32 v4, s48, v4
    v_xor_b32 v5, 64, v4
    v_xor_b32 v6, 0x80, v4
    v_xor_b32 v7, 0xc0, v4
    v_and_b32 v15, 3, v2
    v_mul_u32_u24 v8, 320, v15
    v_lshl_add_u32 v8, v3, 4, v8
    v_add_u32 v8, 131072, v8
    v_lshlrev_b32 v10, 4, v1
    v_add_u32 v10, 132608, v10
    s_lshl_b32 s49, s5, 11
    v_add_u32 v9, s49, v10
    v_lshlrev_b32 v12, 5, v2
    v_add_u32 v12, 140800, v12
    s_lshl_b32 s49, s5, 3
    v_add_u32 v11, s49, v12
    v_lshlrev_b32 v13, 12, v15
    v_lshl_add_u32 v13, v3, 3, v13
    v_bfe_u32 v14, v2, 2, 1
    v_lshl_add_u32 v13, v14, 5, v13
    s_lshl_b32 s49, s5, 6
    v_add_u32 v13, s49, v13
    v_cmp_eq_u32 s[68:69], 1, v14
    v_lshlrev_b32 v14, 7, v15
    v_lshrrev_b32 v224, 2, v2
    v_lshl_add_u32 v224, v3, 2, v224
    v_and_b32 v225, 7, v224
    s_lshl_b32 s49, s5, 1
    v_xor_b32 v225, s49, v225
    v_lshlrev_b32 v224, 8, v224
    v_lshl_add_u32 v224, v225, 5, v224
    v_lshl_add_u32 v224, v15, 3, v224
    v_add_u32 v224, 65536, v224
    v_xor_b32 v225, 32, v224
    s_lshl_b32 s49, s4, 8
    s_add_u32 s56, s56, s49
    s_and_b32 s49, s4, 3
    s_lshl_b32 s49, s49, 5
    s_lshr_b32 s50, s4, 2
    s_lshl_b32 s50, s50, 3
    s_add_u32 s49, s49, s50
    s_add_u32 s83, s49, 3072
    s_mov_b32 s77, 0x3e0293ee
    s_mov_b32 s76, 0xfffefffe
    v_mov_b32 v226, 141312
    v_mov_b32 v232, s77
    s_cmp_eq_u32 s5, 0
    s_cselect_b32 s78, 15, 0
    s_mov_b32 s65, 0
    s_mov_b32 s67, 0
    s_waitcnt vmcnt(0)
    ds_read_b128 v[16:19], v4 offset:0
    ds_read_b128 v[20:23], v5 offset:0
    ds_read_b128 v[24:27], v6 offset:0
    ds_read_b128 v[28:31], v7 offset:0
    ds_read_b128 v[32:35], v4 offset:4096
    ds_read_b128 v[36:39], v5 offset:4096
    ds_read_b128 v[40:43], v6 offset:4096
    ds_read_b128 v[44:47], v7 offset:4096
    ds_read_b128 v[48:51], v4 offset:8192
    ds_read_b128 v[52:55], v5 offset:8192
    ds_read_b128 v[56:59], v6 offset:8192
    ds_read_b128 v[60:63], v7 offset:8192
    ds_read_b128 v[64:67], v4 offset:12288
    ds_read_b128 v[68:71], v5 offset:12288
    ds_read_b128 v[72:75], v6 offset:12288
    ds_read_b128 v[76:79], v7 offset:12288
L_A_b1:
    s_barrier
    ds_read_b128 v[144:147], v8 offset:0
    ds_read_b128 v[148:151], v8 offset:64
    ds_read_b128 v[152:155], v8 offset:128
    ds_read_b128 v[156:159], v8 offset:192
    s_waitcnt lgkmcnt(3)
    v_mfma_f32_16x16x32_bf16 v[160:163], v[16:19], v[144:147], 0
    v_mfma_f32_16x16x32_bf16 v[164:167], v[32:35], v[144:147], 0
    s_waitcnt lgkmcnt(2)
    v_mfma_f32_16x16x32_bf16 v[160:163], v[20:23], v[148:151], v[160:163]
    v_mfma_f32_16x16x32_bf16 v[164:167], v[36:39], v[148:151], v[164:167]
    s_waitcnt lgkmcnt(1)
    v_mfma_f32_16x16x32_bf16 v[160:163], v[24:27], v[152:155], v[160:163]
    v_mfma_f32_16x16x32_bf16 v[164:167], v[40:43], v[152:155], v[164:167]
    s_waitcnt lgkmcnt(0)
    v_mfma_f32_16x16x32_bf16 v[160:163], v[28:31], v[156:159], v[160:163]
    v_mfma_f32_16x16x32_bf16 v[164:167], v[44:47], v[156:159], v[164:167]
    v_mfma_f32_16x16x32_bf16 v[168:171], v[48:51], v[144:147], 0
    v_mfma_f32_16x16x32_bf16 v[172:175], v[64:67], v[144:147], 0
    v_mfma_f32_16x16x32_bf16 v[168:171], v[52:55], v[148:151], v[168:171]
    v_mfma_f32_16x16x32_bf16 v[172:175], v[68:71], v[148:151], v[172:175]
    v_mfma_f32_16x16x32_bf16 v[168:171], v[56:59], v[152:155], v[168:171]
    v_mfma_f32_16x16x32_bf16 v[172:175], v[72:75], v[152:155], v[172:175]
    v_mfma_f32_16x16x32_bf16 v[168:171], v[60:63], v[156:159], v[168:171]
    v_mfma_f32_16x16x32_bf16 v[172:175], v[76:79], v[156:159], v[172:175]
    v_max3_f32 v228, v160, v161, v162
    v_max3_f32 v229, v163, v164, v165
    v_max3_f32 v228, v228, v166, v167
    s_nop 3
    v_max3_f32 v229, v229, v168, v169
    v_max3_f32 v228, v228, v170, v171
    v_max3_f32 v229, v229, v172, v173
    v_max3_f32 v228, v228, v174, v175
    v_max_f32 v228, v228, v229
    v_mov_b32 v229, v228
    s_nop 1
    v_permlane16_swap_b32 v228, v229
    v_max_f32 v228, v228, v229
    v_mov_b32 v229, v228
    s_nop 1
    v_permlane32_swap_b32 v228, v229
    v_max_f32 v228, v228, v229
    v_mul_f32 v230, s77, v228
    v_pk_fma_f32 v[160:161], v[160:161], v[232:233], v[230:231] op_sel_hi:[1,0,0] neg_lo:[0,0,1] neg_hi:[0,0,1]
    v_pk_fma_f32 v[162:163], v[162:163], v[232:233], v[230:231] op_sel_hi:[1,0,0] neg_lo:[0,0,1] neg_hi:[0,0,1]
    v_pk_fma_f32 v[164:165], v[164:165], v[232:233], v[230:231] op_sel_hi:[1,0,0] neg_lo:[0,0,1] neg_hi:[0,0,1]
    v_pk_fma_f32 v[166:167], v[166:167], v[232:233], v[230:231] op_sel_hi:[1,0,0] neg_lo:[0,0,1] neg_hi:[0,0,1]
    v_pk_fma_f32 v[168:169], v[168:169], v[232:233], v[230:231] op_sel_hi:[1,0,0] neg_lo:[0,0,1] neg_hi:[0,0,1]
    v_pk_fma_f32 v[170:171], v[170:171], v[232:233], v[230:231] op_sel_hi:[1,0,0] neg_lo:[0,0,1] neg_hi:[0,0,1]
    v_pk_fma_f32 v[172:173], v[172:173], v[232:233], v[230:231] op_sel_hi:[1,0,0] neg_lo:[0,0,1] neg_hi:[0,0,1]
    v_pk_fma_f32 v[174:175], v[174:175], v[232:233], v[230:231] op_sel_hi:[1,0,0] neg_lo:[0,0,1] neg_hi:[0,0,1]
    v_exp_f32 v160, v160
    v_exp_f32 v161, v161
    v_exp_f32 v162, v162
    v_exp_f32 v163, v163
    v_exp_f32 v164, v164
    v_exp_f32 v165, v165
    v_exp_f32 v166, v166
    v_exp_f32 v167, v167
    v_exp_f32 v168, v168
    v_cvt_pk_bf16_f32 v176, v160, v161
    v_cvt_pk_bf16_f32 v177, v162, v163
    v_cvt_pk_bf16_f32 v178, v164, v165
    v_cvt_pk_bf16_f32 v179, v166, v167
    ds_write_b128 v9, v[176:179]
    v_exp_f32 v169, v169
    v_exp_f32 v170, v170
    v_exp_f32 v171, v171
    v_exp_f32 v172, v172
    v_exp_f32 v173, v173
    v_exp_f32 v174, v174
    v_exp_f32 v175, v175
    v_add_f32 v231, v160, v161
    v_cvt_pk_bf16_f32 v180, v168, v169
    v_cvt_pk_bf16_f32 v181, v170, v171
    v_cvt_pk_bf16_f32 v182, v172, v173
    v_cvt_pk_bf16_f32 v183, v174, v175
    ds_write_b128 v9, v[180:183] offset:1024
    v_pk_add_f32 v[160:161], v[160:161], v[162:163]
    v_pk_add_f32 v[164:165], v[164:165], v[166:167]
    v_pk_add_f32 v[168:169], v[168:169], v[170:171]
    v_pk_add_f32 v[172:173], v[172:173], v[174:175]
    v_pk_add_f32 v[160:161], v[160:161], v[164:165]
    v_pk_add_f32 v[168:169], v[168:169], v[172:173]
    v_pk_add_f32 v[160:161], v[160:161], v[168:169]
    v_add_f32 v231, v160, v161
    v_mov_b32 v229, v231
    s_nop 1
    v_permlane16_swap_b32 v231, v229
    v_add_f32 v231, v231, v229
    v_mov_b32 v229, v231
    s_nop 1
    v_permlane32_swap_b32 v231, v229
    v_add_f32 v231, v231, v229
    ds_write_b64 v11, v[230:231]
    s_waitcnt lgkmcnt(0)
    s_barrier
    ds_read_b32 v227, v226
    ds_read_b128 v[216:219], v12 offset:0
    ds_read_b128 v[220:223], v12 offset:16
    s_cmp_lg_u32 s53, 0
    s_cbranch_scc1 L_A_havev
    ds_read_b128 v[184:187], v10 offset:0
    ds_read_b64_tr_b16 v[80:81], v224 offset:0
    ds_read_b64_tr_b16 v[82:83], v224 offset:4096
    ds_read_b64_tr_b16 v[112:113], v225 offset:0
    ds_read_b64_tr_b16 v[114:115], v225 offset:4096
    ds_read_b128 v[188:191], v10 offset:1024
    ds_read_b64_tr_b16 v[84:85], v224 offset:8192
    ds_read_b64_tr_b16 v[86:87], v224 offset:12288
    ds_read_b64_tr_b16 v[116:117], v225 offset:8192
    ds_read_b64_tr_b16 v[118:119], v225 offset:12288
    s_waitcnt lgkmcnt(10)
    v_readfirstlane_b32 s92, v227
    v_max3_f32 v228, v216, v218, v220
    v_max_f32 v230, v228, v222
    ds_read_b128 v[192:195], v10 offset:2048
    ds_read_b64_tr_b16 v[88:89], v224 offset:16384
    ds_read_b64_tr_b16 v[90:91], v224 offset:20480
    ds_read_b64_tr_b16 v[120:121], v225 offset:16384
    ds_read_b64_tr_b16 v[122:123], v225 offset:20480
    s_waitcnt lgkmcnt(10)
    v_mfma_f32_16x16x32_bf16 v[144:147], v[80:83], v[184:187], 0
    v_sub_f32 v216, v216, v230
    v_mfma_f32_16x16x32_bf16 v[160:163], v[112:115], v[184:187], 0
    v_sub_f32 v218, v218, v230
    ds_read_b128 v[196:199], v10 offset:3072
    ds_read_b64_tr_b16 v[92:93], v224 offset:24576
    ds_read_b64_tr_b16 v[94:95], v224 offset:28672
    ds_read_b64_tr_b16 v[124:125], v225 offset:24576
    ds_read_b64_tr_b16 v[126:127], v225 offset:28672
    s_waitcnt lgkmcnt(10)
    v_mfma_f32_16x16x32_bf16 v[144:147], v[84:87], v[188:191], v[144:147]
    v_sub_f32 v220, v220, v230
    s_cmp_eq_u32 s92, 1
    s_cselect_b32 s64, s78, 0
    v_mfma_f32_16x16x32_bf16 v[160:163], v[116:119], v[188:191], v[160:163]
    v_sub_f32 v222, v222, v230
    s_cselect_b32 s66, 0, s78
    s_cselect_b32 s60, 0x00ff00ff, 0
    ds_read_b128 v[200:203], v10 offset:4096
    ds_read_b64_tr_b16 v[96:97], v224 offset:32768
    ds_read_b64_tr_b16 v[98:99], v224 offset:36864
    ds_read_b64_tr_b16 v[128:129], v225 offset:32768
    ds_read_b64_tr_b16 v[130:131], v225 offset:36864
    s_waitcnt lgkmcnt(10)
    v_mfma_f32_16x16x32_bf16 v[148:151], v[88:91], v[192:195], 0
    v_exp_f32 v216, v216
    s_cselect_b32 s61, 0x00ff00ff, 0
    s_cselect_b32 s62, 0, 0x00ff00ff
    v_mfma_f32_16x16x32_bf16 v[164:167], v[120:123], v[192:195], 0
    v_exp_f32 v218, v218
    s_cselect_b32 s63, 0, 0x00ff00ff
    s_cselect_b32 s50, 0, 524288
    ds_read_b128 v[204:207], v10 offset:5120
    ds_read_b64_tr_b16 v[100:101], v224 offset:40960
    ds_read_b64_tr_b16 v[102:103], v224 offset:45056
    ds_read_b64_tr_b16 v[132:133], v225 offset:40960
    ds_read_b64_tr_b16 v[134:135], v225 offset:45056
    s_waitcnt lgkmcnt(10)
    v_mfma_f32_16x16x32_bf16 v[148:151], v[92:95], v[196:199], v[148:151]
    v_exp_f32 v220, v220
    s_add_u32 s90, s56, s50
    s_add_u32 s50, s52, s50
    v_mfma_f32_16x16x32_bf16 v[164:167], v[124:127], v[196:199], v[164:167]
    v_exp_f32 v222, v222
    s_add_u32 s50, s50, s83
    ds_read_b128 v[208:211], v10 offset:6144
    ds_read_b64_tr_b16 v[104:105], v224 offset:49152
    ds_read_b64_tr_b16 v[106:107], v224 offset:53248
    ds_read_b64_tr_b16 v[136:137], v225 offset:49152
    ds_read_b64_tr_b16 v[138:139], v225 offset:53248
    s_waitcnt lgkmcnt(10)
    v_mfma_f32_16x16x32_bf16 v[152:155], v[96:99], v[200:203], 0
    v_mul_f32 v231, v216, v217
    v_mfma_f32_16x16x32_bf16 v[168:171], v[128:131], v[200:203], 0
    v_fmac_f32 v231, v218, v219
    ds_read_b128 v[212:215], v10 offset:7168
    ds_read_b64_tr_b16 v[108:109], v224 offset:57344
    ds_read_b64_tr_b16 v[110:111], v224 offset:61440
    ds_read_b64_tr_b16 v[140:141], v225 offset:57344
    ds_read_b64_tr_b16 v[142:143], v225 offset:61440
    s_waitcnt lgkmcnt(10)
    v_mfma_f32_16x16x32_bf16 v[152:155], v[100:103], v[204:207], v[152:155]
    v_fmac_f32 v231, v220, v221
    v_mfma_f32_16x16x32_bf16 v[168:171], v[132:135], v[204:207], v[168:171]
    v_fmac_f32 v231, v222, v223
    v_min_u32 v230, -2, v230
    v_min_u32 v231, -2, v231
    s_mov_b64 exec, s[64:65]
    buffer_store_dwordx2 v[230:231], v14, s[32:35], s50 offen
    s_mov_b64 exec, s[66:67]
    buffer_store_dwordx2 v[230:231], v14, s[32:35], s50 offen sc1
    s_mov_b64 exec, -1
    s_waitcnt lgkmcnt(5)
    v_mfma_f32_16x16x32_bf16 v[156:159], v[104:107], v[208:211], 0
    v_mfma_f32_16x16x32_bf16 v[172:175], v[136:139], v[208:211], 0
    s_waitcnt lgkmcnt(0)
    v_mfma_f32_16x16x32_bf16 v[156:159], v[108:111], v[212:215], v[156:159]
    v_mfma_f32_16x16x32_bf16 v[172:175], v[140:143], v[212:215], v[172:175]
    s_branch L_A_comb
L_A_havev:
    ds_read_b128 v[184:187], v10 offset:0
    ds_read_b128 v[188:191], v10 offset:1024
    ds_read_b128 v[192:195], v10 offset:2048
    ds_read_b128 v[196:199], v10 offset:3072
    ds_read_b128 v[200:203], v10 offset:4096
    ds_read_b128 v[204:207], v10 offset:5120
    ds_read_b128 v[208:211], v10 offset:6144
    ds_read_b128 v[212:215], v10 offset:7168
    s_waitcnt lgkmcnt(8)
    v_readfirstlane_b32 s92, v227
    v_max3_f32 v228, v216, v218, v220
    v_max_f32 v230, v228, v222
    s_waitcnt lgkmcnt(7)
    v_mfma_f32_16x16x32_bf16 v[144:147], v[80:83], v[184:187], 0
    v_sub_f32 v216, v216, v230
    v_mfma_f32_16x16x32_bf16 v[160:163], v[112:115], v[184:187], 0
    v_sub_f32 v218, v218, v230
    s_waitcnt lgkmcnt(6)
    v_mfma_f32_16x16x32_bf16 v[144:147], v[84:87], v[188:191], v[144:147]
    v_sub_f32 v220, v220, v230
    s_cmp_eq_u32 s92, 1
    s_cselect_b32 s64, s78, 0
    v_mfma_f32_16x16x32_bf16 v[160:163], v[116:119], v[188:191], v[160:163]
    v_sub_f32 v222, v222, v230
    s_cselect_b32 s66, 0, s78
    s_cselect_b32 s60, 0x00ff00ff, 0
    s_waitcnt lgkmcnt(5)
    v_mfma_f32_16x16x32_bf16 v[148:151], v[88:91], v[192:195], 0
    v_exp_f32 v216, v216
    s_cselect_b32 s61, 0x00ff00ff, 0
    s_cselect_b32 s62, 0, 0x00ff00ff
    v_mfma_f32_16x16x32_bf16 v[164:167], v[120:123], v[192:195], 0
    v_exp_f32 v218, v218
    s_cselect_b32 s63, 0, 0x00ff00ff
    s_cselect_b32 s50, 0, 524288
    s_waitcnt lgkmcnt(4)
    v_mfma_f32_16x16x32_bf16 v[148:151], v[92:95], v[196:199], v[148:151]
    v_exp_f32 v220, v220
    s_add_u32 s90, s56, s50
    s_add_u32 s50, s52, s50
    v_mfma_f32_16x16x32_bf16 v[164:167], v[124:127], v[196:199], v[164:167]
    v_exp_f32 v222, v222
    s_add_u32 s50, s50, s83
    s_waitcnt lgkmcnt(3)
    v_mfma_f32_16x16x32_bf16 v[152:155], v[96:99], v[200:203], 0
    v_mul_f32 v231, v216, v217
    v_mfma_f32_16x16x32_bf16 v[168:171], v[128:131], v[200:203], 0
    v_fmac_f32 v231, v218, v219
    s_waitcnt lgkmcnt(2)
    v_mfma_f32_16x16x32_bf16 v[152:155], v[100:103], v[204:207], v[152:155]
    v_fmac_f32 v231, v220, v221
    v_mfma_f32_16x16x32_bf16 v[168:171], v[132:135], v[204:207], v[168:171]
    v_fmac_f32 v231, v222, v223
    v_min_u32 v230, -2, v230
    v_min_u32 v231, -2, v231
    s_mov_b64 exec, s[64:65]
    buffer_store_dwordx2 v[230:231], v14, s[32:35], s50 offen
    s_mov_b64 exec, s[66:67]
    buffer_store_dwordx2 v[230:231], v14, s[32:35], s50 offen sc1
    s_mov_b64 exec, -1
    s_waitcnt lgkmcnt(1)
    v_mfma_f32_16x16x32_bf16 v[156:159], v[104:107], v[208:211], 0
    v_mfma_f32_16x16x32_bf16 v[172:175], v[136:139], v[208:211], 0
    s_waitcnt lgkmcnt(0)
    v_mfma_f32_16x16x32_bf16 v[156:159], v[108:111], v[212:215], v[156:159]
    v_mfma_f32_16x16x32_bf16 v[172:175], v[140:143], v[212:215], v[172:175]
L_A_comb:
    v_pk_mul_f32 v[176:177], v[144:145], v[216:217] op_sel_hi:[1,0]
    v_pk_mul_f32 v[178:179], v[146:147], v[216:217] op_sel_hi:[1,0]
    v_pk_mul_f32 v[180:181], v[160:161], v[216:217] op_sel_hi:[1,0]
    v_pk_mul_f32 v[182:183], v[162:163], v[216:217] op_sel_hi:[1,0]
    v_pk_fma_f32 v[176:177], v[148:149], v[218:219], v[176:177] op_sel_hi:[1,0,1]
    v_pk_fma_f32 v[178:179], v[150:151], v[218:219], v[178:179] op_sel_hi:[1,0,1]
    v_pk_fma_f32 v[180:181], v[164:165], v[218:219], v[180:181] op_sel_hi:[1,0,1]
    v_pk_fma_f32 v[182:183], v[166:167], v[218:219], v[182:183] op_sel_hi:[1,0,1]
    v_pk_fma_f32 v[176:177], v[152:153], v[220:221], v[176:177] op_sel_hi:[1,0,1]
    v_pk_fma_f32 v[178:179], v[154:155], v[220:221], v[178:179] op_sel_hi:[1,0,1]
    v_pk_fma_f32 v[180:181], v[168:169], v[220:221], v[180:181] op_sel_hi:[1,0,1]
    v_pk_fma_f32 v[182:183], v[170:171], v[220:221], v[182:183] op_sel_hi:[1,0,1]
    v_pk_fma_f32 v[176:177], v[156:157], v[222:223], v[176:177] op_sel_hi:[1,0,1]
    v_pk_fma_f32 v[178:179], v[158:159], v[222:223], v[178:179] op_sel_hi:[1,0,1]
    v_pk_fma_f32 v[180:181], v[172:173], v[222:223], v[180:181] op_sel_hi:[1,0,1]
    v_pk_fma_f32 v[182:183], v[174:175], v[222:223], v[182:183] op_sel_hi:[1,0,1]
    v_cndmask_b32 v176, v176, v180, s[68:69]
    v_cndmask_b32 v177, v177, v181, s[68:69]
    v_cndmask_b32 v178, v178, v182, s[68:69]
    v_cndmask_b32 v179, v179, v183, s[68:69]
    v_cvt_pk_bf16_f32 v176, v176, v177
    v_cvt_pk_bf16_f32 v177, v178, v179
    v_pk_min_u16 v176, v176, s76
    v_pk_min_u16 v177, v177, s76
    s_mov_b64 exec, s[60:61]
    buffer_store_dwordx2 v[176:177], v13, s[32:35], s90 offen
    s_mov_b64 exec, s[62:63]
    buffer_store_dwordx2 v[176:177], v13, s[32:35], s90 offen sc1
    s_mov_b64 exec, -1
    s_add_u32 s56, s56, 196608
    s_add_u32 s52, s52, 196608
    s_add_u32 s53, s53, 1
    s_cmp_lt_u32 s53, 2
    s_cbranch_scc1 L_A_b1
    s_endpgm
L_D2_comp:
    s_setprio 1
    s_min_u32 s49, s6, 6
    s_lshl_b32 s49, s49, 6
    s_mul_i32 s48, s3, 448
    s_add_u32 s80, s48, s49
    s_lshl_b32 s48, s3, 19
    s_lshl_b32 s49, s6, 7
    s_add_u32 s48, s48, s49
    s_sub_u32 s51, 4194304, s48
    s_add_u32 s36, s16, s48
    s_addc_u32 s37, s17, 0
    s_and_b32 s37, s37, 0xffff
    s_mov_b32 s38, s51
    s_mov_b32 s39, 0x00020000
    v_and_b32 v245, 2, v242
    v_xor_b32 v245, v245, v243
    s_and_b32 s49, s5, 1
    s_lshl_b32 s49, s49, 2
    v_xor_b32 v245, s49, v245
    v_lshlrev_b32 v244, 10, v242
    v_lshl_add_u32 v244, v245, 4, v244
    s_lshl_b32 s48, s5, 14
    s_mov_b32 m0, s48
    s_lshl_b32 s49, s5, 17
    s_waitcnt vmcnt(0)
    s_add_u32 s50, s49, 131072
L_D2_wol:
    buffer_load_dwordx4 v244, s[36:39], s49 offen lds
    s_add_u32 m0, m0, 1024
    s_add_u32 s49, s49, 8192
    s_cmp_lt_u32 s49, s50
    s_cbranch_scc1 L_D2_wol
    s_barrier
    s_mov_b32 s44, s22
    s_and_b32 s45, s23, 0xffff
    s_mov_b32 s46, 3584
    s_mov_b32 s47, 0x00020000
    v_and_b32 v54, 7, v2
    v_lshlrev_b32 v54, 1, v54
    s_lshl_b32 s49, s5, 4
    s_add_u32 s48, s80, s49
    buffer_load_ushort v15, v54, s[44:47], s48 offen
    v_lshrrev_b32 v54, 1, v51
    v_lshl_add_u32 v54, v50, 1, v54
    v_xor_b32 v54, s5, v54
    v_lshl_add_u32 v6, v3, 7, v51
    v_lshlrev_b32 v6, 7, v6
    v_lshl_add_u32 v6, v52, 3, v6
    v_lshl_add_u32 v6, v54, 5, v6
    v_bfe_u32 v54, v2, 1, 1
    v_lshl_add_u32 v55, v54, 6, v53
    v_lshl_add_u32 v54, v54, 1, v50
    v_xor_b32 v54, s5, v54
    v_lshlrev_b32 v7, 6, v55
    v_lshl_add_u32 v7, v54, 4, v7
    v_and_b32 v54, 1, v2
    v_lshl_add_u32 v7, v54, 3, v7
    v_add_u32 v7, 65536, v7
    s_lshl_b32 s49, s5, 7
    v_lshlrev_b32 v9, 5, v3
    v_add_u32 v9, s49, v9
    v_lshlrev_b32 v13, 4, v2
    v_lshl_add_u32 v13, v50, 3, v13
    v_lshl_add_u32 v13, v49, 2, v13
    s_lshl_b32 s49, s5, 8
    s_add_u32 s49, s49, 131072
    v_add_u32 v13, s49, v13
    v_add_u32 v8, 131072, v4
    v_lshlrev_b32 v54, 4, v54
    v_mov_b32 v55, 0xffff
    v_lshlrev_b32 v55, v54, v55
    v_bfe_u32 v56, v2, 1, 2
    v_cmp_eq_u32 vcc, 0, v56
    s_nop 1
    v_cndmask_b32 v236, 0, v55, vcc
    v_cmp_eq_u32 vcc, 1, v56
    s_nop 1
    v_cndmask_b32 v237, 0, v55, vcc
    v_cmp_eq_u32 vcc, 2, v56
    s_nop 1
    v_cndmask_b32 v238, 0, v55, vcc
    v_cmp_eq_u32 vcc, 3, v56
    s_nop 1
    v_cndmask_b32 v239, 0, v55, vcc
    v_lshrrev_b32 v248, 3, v2
    v_cmp_eq_u32 vcc, v248, v49
    v_cvt_f32_u32 v248, v248
    s_nop 0
    v_cndmask_b32 v252, 0, -1, vcc
    s_lshl_b32 s49, s5, 12
    s_add_u32 s56, s56, s49
    s_lshl_b32 s49, s7, 4
    s_add_u32 s83, s52, s49
    s_add_u32 s84, s84, 32768
    s_mov_b32 s54, 32768
    s_mov_b32 s78, 0
    s_waitcnt vmcnt(0)
    v_lshlrev_b32 v28, 16, v44
    v_and_b32 v29, 0xffff0000, v44
    v_lshlrev_b32 v30, 16, v45
    v_and_b32 v31, 0xffff0000, v45
    v_lshlrev_b32 v32, 16, v46
    v_and_b32 v33, 0xffff0000, v46
    v_lshlrev_b32 v34, 16, v47
    v_and_b32 v35, 0xffff0000, v47
    v_lshlrev_b32 v15, 16, v15
    s_barrier
    ds_read_b64_tr_b16 v[96:97], v6 offset:0
    ds_read_b64_tr_b16 v[98:99], v6 offset:512
    ds_read_b64_tr_b16 v[100:101], v6 offset:1024
    ds_read_b64_tr_b16 v[102:103], v6 offset:1536
    ds_read_b64_tr_b16 v[104:105], v6 offset:2048
    ds_read_b64_tr_b16 v[106:107], v6 offset:2560
    ds_read_b64_tr_b16 v[108:109], v6 offset:3072
    ds_read_b64_tr_b16 v[110:111], v6 offset:3584
    ds_read_b64_tr_b16 v[112:113], v6 offset:4096
    ds_read_b64_tr_b16 v[114:115], v6 offset:4608
    ds_read_b64_tr_b16 v[116:117], v6 offset:5120
    ds_read_b64_tr_b16 v[118:119], v6 offset:5632
    ds_read_b64_tr_b16 v[120:121], v6 offset:6144
    ds_read_b64_tr_b16 v[122:123], v6 offset:6656
    ds_read_b64_tr_b16 v[124:125], v6 offset:7168
    ds_read_b64_tr_b16 v[126:127], v6 offset:7680
    ds_read_b64_tr_b16 v[128:129], v6 offset:8192
    ds_read_b64_tr_b16 v[130:131], v6 offset:8704
    ds_read_b64_tr_b16 v[132:133], v6 offset:9216
    ds_read_b64_tr_b16 v[134:135], v6 offset:9728
    ds_read_b64_tr_b16 v[136:137], v6 offset:10240
    ds_read_b64_tr_b16 v[138:139], v6 offset:10752
    ds_read_b64_tr_b16 v[140:141], v6 offset:11264
    ds_read_b64_tr_b16 v[142:143], v6 offset:11776
    ds_read_b64_tr_b16 v[144:145], v6 offset:12288
    ds_read_b64_tr_b16 v[146:147], v6 offset:12800
    ds_read_b64_tr_b16 v[148:149], v6 offset:13312
    ds_read_b64_tr_b16 v[150:151], v6 offset:13824
    ds_read_b64_tr_b16 v[152:153], v6 offset:14336
    ds_read_b64_tr_b16 v[154:155], v6 offset:14848
    ds_read_b64_tr_b16 v[156:157], v6 offset:15360
    ds_read_b64_tr_b16 v[158:159], v6 offset:15872
    ds_read_b64_tr_b16 v[192:193], v7 offset:0
    ds_read_b64_tr_b16 v[194:195], v7 offset:16384
    ds_read_b64_tr_b16 v[196:197], v7 offset:512
    ds_read_b64_tr_b16 v[198:199], v7 offset:16896
    ds_read_b64_tr_b16 v[200:201], v7 offset:1024
    ds_read_b64_tr_b16 v[202:203], v7 offset:17408
    ds_read_b64_tr_b16 v[204:205], v7 offset:1536
    ds_read_b64_tr_b16 v[206:207], v7 offset:17920
    ds_read_b64_tr_b16 v[208:209], v7 offset:2048
    ds_read_b64_tr_b16 v[210:211], v7 offset:18432
    ds_read_b64_tr_b16 v[212:213], v7 offset:2560
    ds_read_b64_tr_b16 v[214:215], v7 offset:18944
    ds_read_b64_tr_b16 v[216:217], v7 offset:3072
    ds_read_b64_tr_b16 v[218:219], v7 offset:19456
    ds_read_b64_tr_b16 v[220:221], v7 offset:3584
    ds_read_b64_tr_b16 v[222:223], v7 offset:19968
    v_mov_b32 v49, 141312
    ds_read_b32 v50, v49
    s_waitcnt lgkmcnt(0)
    v_readfirstlane_b32 s92, v50
    s_cmp_eq_u32 s7, 28
    s_cselect_b32 s49, -1, 0
    s_nop 2
    s_cmp_eq_u32 s92, 1
    s_cselect_b32 s60, 0xff, 0
    s_cselect_b32 s61, 0, 0
    s_cselect_b32 s62, 0, 0xff
    s_cselect_b32 s63, 0, 0
    s_cselect_b32 s64, s49, 0
    s_cselect_b32 s65, s49, 0
    s_cselect_b32 s66, 0, s49
    s_cselect_b32 s67, 0, s49
    s_cselect_b32 s49, 0, 524288
    s_add_u32 s52, s52, s49
    s_add_u32 s56, s56, s49
    s_add_u32 s83, s83, s49
    v_mfma_f32_16x16x32_bf16 v[160:163], v[24:27], v[192:195], 0
    v_mfma_f32_16x16x32_bf16 v[160:163], v[24:27], v[196:199], v[160:163]
    v_mfma_f32_16x16x32_bf16 v[160:163], v[24:27], v[200:203], v[160:163]
    v_mfma_f32_16x16x32_bf16 v[160:163], v[24:27], v[204:207], v[160:163]
    v_mfma_f32_16x16x32_bf16 v[160:163], v[24:27], v[208:211], v[160:163]
    v_mfma_f32_16x16x32_bf16 v[160:163], v[24:27], v[212:215], v[160:163]
    v_mfma_f32_16x16x32_bf16 v[160:163], v[24:27], v[216:219], v[160:163]
    v_mfma_f32_16x16x32_bf16 v[160:163], v[24:27], v[220:223], v[160:163]
    s_nop 7
    v_add_f32_dpp v0, v160, v160 row_ror:8 row_mask:0xf bank_mask:0xf
L_D2_loop:
    v_mov_b32 v224, -1
    v_mov_b32 v225, -1
    v_mov_b32 v226, -1
    v_mov_b32 v227, -1
    v_mov_b32 v228, -1
    v_mov_b32 v229, -1
    v_mov_b32 v230, -1
    v_mov_b32 v231, -1
    buffer_load_dwordx4 v[64:67], v4, s[32:35], s56 offen offset:0 sc1
    buffer_load_dwordx4 v[68:71], v4, s[32:35], s56 offen offset:1024 sc1
    buffer_load_dwordx4 v[72:75], v4, s[32:35], s56 offen offset:2048 sc1
    buffer_load_dwordx4 v[76:79], v4, s[32:35], s56 offen offset:3072 sc1
L_gs_poll:
    buffer_load_dwordx4 v[224:227], v9, s[32:35], s52 offen offset:3072 sc1
    buffer_load_dwordx4 v[228:231], v9, s[32:35], s52 offen offset:3088 sc1
    s_waitcnt vmcnt(4)
    v_max3_u32 v49, v224, v225, v226
    v_max3_u32 v50, v227, v228, v229
    v_max3_u32 v49, v49, v230, v231
    v_max_u32 v49, v49, v50
    v_cmp_eq_u32 vcc, -1, v49
    s_cbranch_vccz L_gs_ok
    s_sub_u32 s57, s57, 1
    s_cbranch_scc1 L_exit
    s_branch L_gs_poll
L_gs_ok:
    buffer_load_dwordx4 v[64:67], v4, s[32:35], s56 offen offset:0 sc1
    buffer_load_dwordx4 v[68:71], v4, s[32:35], s56 offen offset:1024 sc1
    buffer_load_dwordx4 v[72:75], v4, s[32:35], s56 offen offset:2048 sc1
    buffer_load_dwordx4 v[76:79], v4, s[32:35], s56 offen offset:3072 sc1
    v_max3_f32 v49, v224, v226, v228
    v_max_f32 v49, v49, v230
    v_mov_b32 v50, v49
    s_nop 1
    v_permlane16_swap_b32 v49, v50
    v_max_f32 v49, v49, v50
    v_mov_b32 v50, v49
    s_nop 1
    v_permlane32_swap_b32 v49, v50
    v_max_f32 v49, v49, v50
    v_sub_f32 v52, v224, v49
    v_sub_f32 v53, v226, v49
    v_sub_f32 v54, v228, v49
    v_sub_f32 v55, v230, v49
    v_exp_f32 v52, v52
    v_exp_f32 v53, v53
    v_exp_f32 v54, v54
    v_exp_f32 v55, v55
    s_nop 0
    v_mul_f32 v51, v52, v225
    v_fmac_f32 v51, v53, v227
    v_fmac_f32 v51, v54, v229
    v_fmac_f32 v51, v55, v231
    v_mov_b32 v50, v51
    s_nop 1
    v_permlane16_swap_b32 v51, v50
    v_add_f32 v51, v51, v50
    v_mov_b32 v50, v51
    s_nop 1
    v_permlane32_swap_b32 v51, v50
    v_add_f32 v51, v51, v50
    v_rcp_f32 v51, v51
    buffer_load_dwordx4 v[64:67], v4, s[32:35], s56 offen offset:0 sc1
    buffer_load_dwordx4 v[68:71], v4, s[32:35], s56 offen offset:1024 sc1
    buffer_load_dwordx4 v[72:75], v4, s[32:35], s56 offen offset:2048 sc1
    buffer_load_dwordx4 v[76:79], v4, s[32:35], s56 offen offset:3072 sc1
    v_mul_f32 v52, v52, v51
    v_mul_f32 v53, v53, v51
    v_mul_f32 v54, v54, v51
    v_mul_f32 v55, v55, v51
    v_cvt_pk_bf16_f32 v56, v52, v52
    v_cvt_pk_bf16_f32 v57, v53, v53
    v_cvt_pk_bf16_f32 v58, v54, v54
    v_cvt_pk_bf16_f32 v59, v55, v55
    v_and_b32 v56, 0xffff0000, v56
    v_and_b32 v57, 0xffff0000, v57
    v_and_b32 v58, 0xffff0000, v58
    v_and_b32 v59, 0xffff0000, v59
    v_fma_f32 v52, -v56, v248, v52
    v_fma_f32 v53, -v57, v248, v53
    v_fma_f32 v54, -v58, v248, v54
    v_fma_f32 v55, -v59, v248, v55
    v_cvt_pk_bf16_f32 v52, v52, v52
    v_cvt_pk_bf16_f32 v53, v53, v53
    v_cvt_pk_bf16_f32 v54, v54, v54
    v_cvt_pk_bf16_f32 v55, v55, v55
    v_and_b32 v80, v236, v52
    v_and_b32 v81, v237, v52
    v_and_b32 v82, v238, v52
    v_and_b32 v83, v239, v52
    v_and_b32 v84, v236, v53
    v_and_b32 v85, v237, v53
    v_and_b32 v86, v238, v53
    v_and_b32 v87, v239, v53
    v_and_b32 v88, v236, v54
    v_and_b32 v89, v237, v54
    v_and_b32 v90, v238, v54
    v_and_b32 v91, v239, v54
    v_and_b32 v92, v236, v55
    v_and_b32 v93, v237, v55
    v_and_b32 v94, v238, v55
    v_and_b32 v95, v239, v55
    s_branch L_gp_use
L_gp_nan:
    s_sub_u32 s57, s57, 1
    s_cbranch_scc1 L_exit
    s_and_b32 s49, s57, 15
    s_cbranch_scc0 L_gp_retry
L_gp_again:
    buffer_load_dwordx4 v[64:67], v4, s[32:35], s56 offen offset:0 sc1
    buffer_load_dwordx4 v[68:71], v4, s[32:35], s56 offen offset:1024 sc1
    buffer_load_dwordx4 v[72:75], v4, s[32:35], s56 offen offset:2048 sc1
    buffer_load_dwordx4 v[76:79], v4, s[32:35], s56 offen offset:3072 sc1
L_gp_use:
    s_waitcnt vmcnt(4)
    v_mfma_f32_16x16x32_bf16 v[232:235], v[80:83], v[64:67], 0
    v_mfma_f32_16x16x32_bf16 v[232:235], v[84:87], v[68:71], v[232:235]
    v_mfma_f32_16x16x32_bf16 v[232:235], v[88:91], v[72:75], v[232:235]
    v_mfma_f32_16x16x32_bf16 v[232:235], v[92:95], v[76:79], v[232:235]
    s_nop 7
    v_cmp_u_f32 vcc, v232, v232
    v_permlane32_swap_b32 v232, v234
    v_permlane32_swap_b32 v233, v235
    s_cbranch_vccnz L_gp_nan
L_gp_ok:
    v_add_f32 v232, v232, v234
    v_add_f32 v233, v233, v235
    v_cvt_pk_bf16_f32 v232, v232, v233
    ds_write_b32 v13, v232
    v_mov_b32 v48, 0
    s_waitcnt lgkmcnt(0)
    s_barrier
    ds_read_b128 v[44:47], v8
    buffer_load_dwordx4 v[232:235], v4, s[32:35], s52 offen offset:1024 sc1
    s_waitcnt lgkmcnt(0)
    v_mfma_f32_16x16x32_bf16 v[160:163], v[44:47], v[96:99], 0
    s_nop 3
    v_mfma_f32_16x16x32_bf16 v[164:167], v[44:47], v[100:103], 0
    s_nop 3
    v_mfma_f32_16x16x32_bf16 v[168:171], v[44:47], v[104:107], 0
    s_nop 2
    v_add_f32_dpp v48, v160, v165 quad_perm:[0,1,2,3] row_mask:0x1 bank_mask:0xf
    v_mfma_f32_16x16x32_bf16 v[172:175], v[44:47], v[108:111], 0
    s_nop 2
    v_add_f32_dpp v48, v170, v48 quad_perm:[0,1,2,3] row_mask:0x1 bank_mask:0xf
    v_mfma_f32_16x16x32_bf16 v[176:179], v[44:47], v[112:115], 0
    s_nop 2
    v_add_f32_dpp v48, v175, v48 quad_perm:[0,1,2,3] row_mask:0x1 bank_mask:0xf
    v_mfma_f32_16x16x32_bf16 v[180:183], v[44:47], v[116:119], 0
    s_nop 3
    v_mfma_f32_16x16x32_bf16 v[184:187], v[44:47], v[120:123], 0
    s_nop 2
    v_add_f32_dpp v48, v176, v181 quad_perm:[0,1,2,3] row_mask:0x2 bank_mask:0xf
    v_mfma_f32_16x16x32_bf16 v[188:191], v[44:47], v[124:127], 0
    s_nop 2
    v_add_f32_dpp v48, v186, v48 quad_perm:[0,1,2,3] row_mask:0x2 bank_mask:0xf
    v_mfma_f32_16x16x32_bf16 v[160:163], v[44:47], v[128:131], 0
    s_nop 2
    v_add_f32_dpp v48, v191, v48 quad_perm:[0,1,2,3] row_mask:0x2 bank_mask:0xf
    v_mfma_f32_16x16x32_bf16 v[164:167], v[44:47], v[132:135], 0
    s_nop 3
    v_mfma_f32_16x16x32_bf16 v[168:171], v[44:47], v[136:139], 0
    s_nop 2
    v_add_f32_dpp v48, v160, v165 quad_perm:[0,1,2,3] row_mask:0x4 bank_mask:0xf
    v_mfma_f32_16x16x32_bf16 v[172:175], v[44:47], v[140:143], 0
    s_nop 2
    v_add_f32_dpp v48, v170, v48 quad_perm:[0,1,2,3] row_mask:0x4 bank_mask:0xf
    v_mfma_f32_16x16x32_bf16 v[176:179], v[44:47], v[144:147], 0
    s_nop 2
    v_add_f32_dpp v48, v175, v48 quad_perm:[0,1,2,3] row_mask:0x4 bank_mask:0xf
    v_mfma_f32_16x16x32_bf16 v[180:183], v[44:47], v[148:151], 0
    s_nop 3
    v_mfma_f32_16x16x32_bf16 v[184:187], v[44:47], v[152:155], 0
    s_nop 2
    v_add_f32_dpp v48, v176, v181 quad_perm:[0,1,2,3] row_mask:0x8 bank_mask:0xf
    v_mfma_f32_16x16x32_bf16 v[188:191], v[44:47], v[156:159], 0
    s_nop 2
    v_add_f32_dpp v48, v186, v48 quad_perm:[0,1,2,3] row_mask:0x8 bank_mask:0xf
    s_nop 3
    v_add_f32_dpp v48, v191, v48 quad_perm:[0,1,2,3] row_mask:0x8 bank_mask:0xf
    v_mov_b32 v54, v48
    s_nop 1
    v_permlane16_swap_b32 v48, v54
    v_add_f32 v48, v48, v54
    v_mov_b32 v54, v48
    s_nop 1
    v_permlane32_swap_b32 v48, v54
    v_add_f32 v48, v48, v54
    s_nop 1
    v_mov_b32_dpp v54, v48 quad_perm:[1,1,3,3] row_mask:0xf bank_mask:0xf
    s_mov_b64 exec, 0x5555
    v_cvt_pk_bf16_f32 v48, v48, v54
    v_pk_min_u16 v48, v48, s76
    buffer_store_dword v48, v10, s[32:35], s84 offen sc1
    s_mov_b64 exec, -1
    v_mov_b32 v48, 0
    s_cmp_lg_u32 s5, 0
    s_cbranch_scc1 L_gy_other
    s_cmp_eq_u32 s53, 0
    s_cbranch_scc1 L_D2_havex
    s_waitcnt vmcnt(1)
    v_pk_max_u16 v49, v232, v233
    v_pk_max_u16 v50, v234, v235
    v_pk_max_u16 v49, v49, v50
    v_pk_max_u16 v49, v49, v49 op_sel:[0,1] op_sel_hi:[1,0]
    v_cmp_eq_u32 vcc, -1, v49
    s_cbranch_vccz L_gx2_have
L_gx2_poll:
    buffer_load_dwordx4 v[232:235], v4, s[32:35], s52 offen offset:1024 sc1
    s_waitcnt vmcnt(0)
    v_pk_max_u16 v49, v232, v233
    v_pk_max_u16 v50, v234, v235
    v_pk_max_u16 v49, v49, v50
    v_pk_max_u16 v49, v49, v49 op_sel:[0,1] op_sel_hi:[1,0]
    v_cmp_eq_u32 vcc, -1, v49
    s_cbranch_vccz L_gx2_ok
    s_sub_u32 s57, s57, 1
    s_cbranch_scc1 L_exit
    s_branch L_gx2_poll
L_gx2_ok:
L_gx2_have:
    v_lshlrev_b32 v28, 16, v232
    v_and_b32 v29, 0xffff0000, v232
    v_lshlrev_b32 v30, 16, v233
    v_and_b32 v31, 0xffff0000, v233
    v_lshlrev_b32 v32, 16, v234
    v_and_b32 v33, 0xffff0000, v234
    v_lshlrev_b32 v34, 16, v235
    v_and_b32 v35, 0xffff0000, v235
L_D2_havex:
    s_add_u32 s48, s54, 4096
    s_waitcnt vmcnt(0)
    s_branch L_gy_again
L_gy_nan:
    s_sub_u32 s57, s57, 1
    s_cbranch_scc1 L_exit
    s_and_b32 s49, s57, 15
    s_cbranch_scc0 L_gy_retry
L_gy_again:
    buffer_load_dwordx4 v[64:67], v249, s[32:35], s54 offen offset:0 sc1
    buffer_load_dwordx4 v[68:71], v249, s[32:35], s54 offen offset:256 sc1
    buffer_load_dwordx4 v[72:75], v249, s[32:35], s54 offen offset:512 sc1
    buffer_load_dwordx4 v[76:79], v249, s[32:35], s54 offen offset:768 sc1
    buffer_load_dwordx4 v[80:83], v249, s[32:35], s48 offen offset:0 sc1
    buffer_load_dwordx4 v[84:87], v249, s[32:35], s48 offen offset:256 sc1
    buffer_load_dwordx4 v[88:91], v249, s[32:35], s48 offen offset:512 sc1
    buffer_load_dwordx4 v[92:95], v249, s[32:35], s48 offen offset:768 sc1
    s_waitcnt vmcnt(7)
    v_mfma_f32_16x16x32_bf16 v[36:39], v[16:19], v[64:67], v[28:31]
    s_waitcnt vmcnt(6)
    v_mfma_f32_16x16x32_bf16 v[36:39], v[20:23], v[68:71], v[36:39]
    s_waitcnt vmcnt(5)
    v_mfma_f32_16x16x32_bf16 v[40:43], v[16:19], v[72:75], v[32:35]
    s_waitcnt vmcnt(4)
    v_mfma_f32_16x16x32_bf16 v[40:43], v[20:23], v[76:79], v[40:43]
    s_waitcnt vmcnt(3)
    v_mfma_f32_16x16x32_bf16 v[36:39], v[16:19], v[80:83], v[36:39]
    s_waitcnt vmcnt(2)
    v_mfma_f32_16x16x32_bf16 v[36:39], v[20:23], v[84:87], v[36:39]
    s_waitcnt vmcnt(1)
    v_mfma_f32_16x16x32_bf16 v[40:43], v[16:19], v[88:91], v[40:43]
    s_waitcnt vmcnt(0)
    v_mfma_f32_16x16x32_bf16 v[40:43], v[20:23], v[92:95], v[40:43]
    s_nop 6
    v_cmp_u_f32 vcc, v36, v36
    v_cmp_u_f32 s[80:81], v40, v40
    v_cvt_pk_bf16_f32 v44, v36, v37
    v_cvt_pk_bf16_f32 v45, v38, v39
    v_cvt_pk_bf16_f32 v46, v40, v41
    v_cvt_pk_bf16_f32 v47, v42, v43
    s_or_b64 vcc, vcc, s[80:81]
    s_cbranch_vccnz L_gy_nan
L_gy_ok:
    ds_write_b128 v14, v[44:47]
    s_waitcnt lgkmcnt(0)
    s_barrier
    s_branch L_gy_join
L_gy_other:
    s_waitcnt vmcnt(0)
    s_barrier
    ds_read_b128 v[44:47], v14
    s_waitcnt lgkmcnt(0)
L_gy_join:
    s_cmp_eq_u32 s6, 7
    s_cbranch_scc1 L_D2_x1
    v_mfma_f32_16x16x32_bf16 v[160:163], v[44:47], v[192:195], 0
    v_lshlrev_b32 v28, 16, v44
    v_and_b32 v29, 0xffff0000, v44
    v_readfirstlane_b32 s82, v28
    v_lshlrev_b32 v30, 16, v45
    v_and_b32 v31, 0xffff0000, v45
    v_mfma_f32_16x16x32_bf16 v[164:167], v[44:47], v[196:199], 0
    v_lshlrev_b32 v32, 16, v46
    v_and_b32 v33, 0xffff0000, v46
    v_lshlrev_b32 v34, 16, v47
    v_and_b32 v35, 0xffff0000, v47
    v_pk_add_f32 v[36:37], v[28:29], s[82:83] op_sel_hi:[1,0] neg_lo:[0,1] neg_hi:[0,1]
    v_mfma_f32_16x16x32_bf16 v[168:171], v[44:47], v[200:203], 0
    v_pk_add_f32 v[38:39], v[30:31], s[82:83] op_sel_hi:[1,0] neg_lo:[0,1] neg_hi:[0,1]
    v_pk_add_f32 v[40:41], v[32:33], s[82:83] op_sel_hi:[1,0] neg_lo:[0,1] neg_hi:[0,1]
    v_add_f32_dpp v48, v160, v165 quad_perm:[0,1,2,3] row_mask:0x5 bank_mask:0xf
    v_pk_add_f32 v[42:43], v[34:35], s[82:83] op_sel_hi:[1,0] neg_lo:[0,1] neg_hi:[0,1]
    v_pk_add_f32 v[50:51], v[36:37], v[38:39]
    v_mfma_f32_16x16x32_bf16 v[172:175], v[44:47], v[204:207], 0
    v_pk_mul_f32 v[52:53], v[36:37], v[36:37]
    v_pk_fma_f32 v[52:53], v[38:39], v[38:39], v[52:53]
    v_add_f32_dpp v48, v170, v48 quad_perm:[0,1,2,3] row_mask:0x5 bank_mask:0xf
    v_pk_fma_f32 v[52:53], v[40:41], v[40:41], v[52:53]
    v_pk_add_f32 v[50:51], v[50:51], v[40:41]
    v_mfma_f32_16x16x32_bf16 v[176:179], v[44:47], v[208:211], 0
    v_pk_fma_f32 v[52:53], v[42:43], v[42:43], v[52:53]
    v_pk_add_f32 v[50:51], v[50:51], v[42:43]
    v_add_f32_dpp v48, v175, v48 quad_perm:[0,1,2,3] row_mask:0x5 bank_mask:0xf
    v_add_f32 v52, v52, v53
    v_add_f32 v50, v50, v51
    v_mfma_f32_16x16x32_bf16 v[180:183], v[44:47], v[212:215], 0
    s_nop 0
    v_add_f32_dpp v52, v52, v52 quad_perm:[1,0,3,2] row_mask:0xf bank_mask:0xf
    v_add_f32_dpp v50, v50, v50 quad_perm:[1,0,3,2] row_mask:0xf bank_mask:0xf
    s_nop 0
    v_add_f32_dpp v52, v52, v52 quad_perm:[2,3,0,1] row_mask:0xf bank_mask:0xf
    v_mfma_f32_16x16x32_bf16 v[184:187], v[44:47], v[216:219], 0
    v_add_f32_dpp v50, v50, v50 quad_perm:[2,3,0,1] row_mask:0xf bank_mask:0xf
    s_nop 0
    v_add_f32_dpp v48, v176, v181 quad_perm:[0,1,2,3] row_mask:0xa bank_mask:0xf
    v_add_f32_dpp v52, v52, v52 row_half_mirror row_mask:0xf bank_mask:0xf
    v_add_f32_dpp v50, v50, v50 row_half_mirror row_mask:0xf bank_mask:0xf
    v_mfma_f32_16x16x32_bf16 v[188:191], v[44:47], v[220:223], 0
    s_nop 0
    v_add_f32_dpp v52, v52, v52 row_mirror row_mask:0xf bank_mask:0xf
    v_add_f32_dpp v48, v186, v48 quad_perm:[0,1,2,3] row_mask:0xa bank_mask:0xf
    v_add_f32_dpp v50, v50, v50 row_mirror row_mask:0xf bank_mask:0xf
    s_nop 0
    v_add_f32_dpp v52, v52, v52 row_bcast:15 row_mask:0xa bank_mask:0xf
    v_add_f32_dpp v50, v50, v50 row_bcast:15 row_mask:0xa bank_mask:0xf
    s_nop 0
    v_add_f32_dpp v48, v191, v48 quad_perm:[0,1,2,3] row_mask:0xa bank_mask:0xf
    v_add_f32_dpp v52, v52, v52 row_bcast:31 row_mask:0xc bank_mask:0xf
    v_add_f32_dpp v50, v50, v50 row_bcast:31 row_mask:0xc bank_mask:0xf
    s_nop 0
    v_readlane_b32 s81, v52, 63
    v_readlane_b32 s80, v50, 63
    s_nop 0
    v_fma_f32 v52, s81, v250, v251
    v_mul_f32 v51, s80, v250
    v_fma_f32 v52, -v51, v51, v52
    v_max_f32 v52, v251, v52
    v_rsq_f32 v52, v52
    v_add_f32 v51, s82, v51
    v_and_b32 v48, v252, v48
    v_mov_b32 v54, v48
    s_nop 1
    v_permlane16_swap_b32 v48, v54
    v_add_f32 v48, v48, v54
    v_mov_b32 v54, v48
    s_nop 1
    v_permlane32_swap_b32 v48, v54
    v_add_f32 v48, v48, v54
    s_nop 1
    v_add_f32_dpp v48, v48, v48 row_ror:8 row_mask:0xf bank_mask:0xf
    v_fma_f32 v48, -v51, v0, v48
    v_mul_f32 v48, v48, v52
    v_add_f32 v48, v48, v15
    v_mul_f32 v54, s79, |v48|
    v_exp_f32 v54, v54
    v_cmp_le_f32 vcc, 0, v48
    v_add_f32 v56, 2.0, v54
    v_fma_f32 v55, v54, 2.0, 1.0
    v_mul_f32 v56, v54, v56
    v_mul_f32 v54, v54, v54
    v_cndmask_b32 v55, v56, v55, vcc
    v_cndmask_b32 v54, 1.0, v54, vcc
    v_fma_f32 v56, v54, 2.0, v55
    v_rcp_f32 v56, v56
    v_mul_f32 v48, v48, v55
    v_mul_f32 v48, v48, v56
    v_cvt_pk_bf16_f32 v48, v48, v48
    v_min_u32 v48, -2, v48
    s_mov_b64 exec, s[60:61]
    buffer_store_short v48, v10, s[32:35], s83 offen offset:3584
    s_mov_b64 exec, s[62:63]
    buffer_store_short v48, v10, s[32:35], s83 offen offset:3584 sc1
    s_mov_b64 exec, -1
L_D2_next:
    s_add_u32 s52, s52, 196608
    s_add_u32 s56, s56, 196608
    s_add_u32 s83, s83, 196608
    s_add_u32 s84, s84, 196608
    s_add_u32 s54, s54, 196608
    s_add_u32 s53, s53, 1
    s_cmp_lt_u32 s53, 2
    s_cbranch_scc1 L_D2_loop
    s_endpgm
L_D2_x1:
    v_pk_min_u16 v56, v44, s76
    v_pk_min_u16 v57, v45, s76
    v_pk_min_u16 v58, v46, s76
    v_pk_min_u16 v59, v47, s76
    s_mov_b64 exec, s[64:65]
    buffer_store_dwordx4 v[56:59], v4, s[32:35], s52 offen offset:2048
    s_mov_b64 exec, s[66:67]
    buffer_store_dwordx4 v[56:59], v4, s[32:35], s52 offen offset:2048 sc1
    s_mov_b64 exec, -1
    v_lshlrev_b32 v28, 16, v44
    v_and_b32 v29, 0xffff0000, v44
    v_lshlrev_b32 v30, 16, v45
    v_and_b32 v31, 0xffff0000, v45
    v_lshlrev_b32 v32, 16, v46
    v_and_b32 v33, 0xffff0000, v46
    v_lshlrev_b32 v34, 16, v47
    v_and_b32 v35, 0xffff0000, v47
    s_branch L_D2_next
L_D1_help:
    s_mul_i32 s48, s3, 229376
    s_lshl_b32 s49, s6, 7
    s_add_u32 s48, s48, s49
    s_add_u32 s40, s24, s48
    s_addc_u32 s41, s25, 0
    s_and_b32 s41, s41, 0xffff
    s_mov_b32 s42, 228480
    s_mov_b32 s43, 0x00020000
    v_lshlrev_b32 v244, 10, v242
    v_lshl_add_u32 v244, v243, 4, v244
    s_cmp_eq_u32 s5, 4
    s_cbranch_scc1 L_D1_ctl
    v_lshlrev_b32 v245, 12, v1
    buffer_load_dword v255, v245, s[40:43], 0 offen
    s_cmp_lg_u32 s5, 5
    s_cbranch_scc1 L_D1_wm0
L_D1_wm0:
    s_cmp_lg_u32 s5, 6
    s_cbranch_scc1 L_D1_wm1
L_D1_wm1:
    s_cmp_lg_u32 s5, 7
    s_cbranch_scc1 L_D1_wm2
L_D1_wm2:
    s_branch L_D1_bq
L_D1_ctl:
    v_lshlrev_b32 v224, 7, v2
    buffer_load_dword v240, v224, s[32:35], s74 offen sc1
    s_waitcnt vmcnt(0)
    v_readfirstlane_b32 s72, v241
    v_mov_b32 v212, -1
    v_mov_b32 v213, -1
    v_mov_b32 v214, -1
    v_mov_b32 v215, -1
    s_add_u32 s72, s72, 1
    s_getreg_b32 s73, hwreg(HW_REG_XCC_ID, 0, 4)
    v_mov_b32 v209, s72
    s_lshl_b32 s51, s4, 3
    v_mov_b32 v208, s73
    v_mov_b32 v210, s51
    s_mov_b64 exec, 1
    buffer_store_dwordx2 v[208:209], v210, s[32:35], s74 offen offset:2048
    s_mov_b64 exec, -1
L_D1_bq:
    s_barrier
    s_cmp_lg_u32 s5, 4
    s_cbranch_scc1 L_D1_w2
    s_sub_u32 s81, s57, 160
    v_and_b32 v211, 31, v1
    v_lshlrev_b32 v211, 3, v211
    s_not_b32 s49, s72
    v_mov_b32 v221, s49
L_d1x_poll:
    buffer_load_dwordx2 v[220:221], v211, s[32:35], s74 offen offset:2048 sc1
    s_waitcnt vmcnt(6)
    v_cmp_ne_u32 vcc, s72, v221
    s_cbranch_vccz L_d1x_seen
    s_sleep 3
    s_cmp_gt_u32 s57, s81
    s_cbranch_scc0 L_d1x_b
    s_sub_u32 s57, s57, 1
    s_cbranch_scc1 L_exit
    s_branch L_d1x_poll
L_d1x_seen:
    s_nop 15
L_d1x_ok:
    v_cmp_ne_u32 vcc, s73, v220
    s_nop 3
    s_cmp_eq_u64 vcc, 0
    s_cselect_b32 s92, 1, 0
    s_cbranch_scc0 L_d1x_slow
L_d1x_done:
    v_mov_b32 v226, 141312
    v_mov_b32 v227, s92
    ds_write_b32 v226, v227
    v_lshlrev_b32 v224, 3, v1
    s_cmp_eq_u32 s92, 1
    s_cbranch_scc0 L_D1_b2
L_D1_st:
    buffer_load_dword v225, v224, s[32:35], s52 offen offset:3072 sc1
    s_waitcnt vmcnt(0)
    v_cmp_ne_u32 vcc, -1, v225
    s_cbranch_vccnz L_D1_b2
    s_sleep 8
    s_sub_u32 s57, s57, 1
    s_cbranch_scc1 L_exit
    s_branch L_D1_st
L_D1_b2:
    s_waitcnt lgkmcnt(0)
L_D1_w2:
    s_barrier
    s_sub_u32 s48, s5, 4
    s_mul_i32 s49, s48, 7168
    s_add_u32 m0, s49, 65536
    s_mul_i32 s49, s48, 57344
    buffer_load_dwordx4 v244, s[40:43], s49 offen lds
    s_add_u32 m0, m0, 1024
    s_add_u32 s49, s49, 8192
    buffer_load_dwordx4 v244, s[40:43], s49 offen lds
    s_add_u32 m0, m0, 1024
    s_add_u32 s49, s49, 8192
    buffer_load_dwordx4 v244, s[40:43], s49 offen lds
    s_add_u32 m0, m0, 1024
    s_add_u32 s49, s49, 8192
    buffer_load_dwordx4 v244, s[40:43], s49 offen lds
    s_add_u32 m0, m0, 1024
    s_add_u32 s49, s49, 8192
    buffer_load_dwordx4 v244, s[40:43], s49 offen lds
    s_add_u32 m0, m0, 1024
    s_add_u32 s49, s49, 8192
    buffer_load_dwordx4 v244, s[40:43], s49 offen lds
    s_add_u32 m0, m0, 1024
    s_add_u32 s49, s49, 8192
    buffer_load_dwordx4 v244, s[40:43], s49 offen lds
    s_waitcnt vmcnt(0) lgkmcnt(0)
    s_barrier
    s_endpgm
L_D2_init:
    s_min_u32 s49, s6, 6
    s_lshl_b32 s49, s49, 6
    s_mul_i32 s48, s3, 448
    s_add_u32 s80, s48, s49
    s_sub_u32 s51, 1835008, s80
    s_add_u32 s40, s20, s80
    s_addc_u32 s41, s21, 0
    s_and_b32 s41, s41, 0xffff
    s_mov_b32 s42, s51
    s_mov_b32 s43, 0x00020000
    s_mov_b32 s44, s28
    s_and_b32 s45, s29, 0xffff
    s_mov_b32 s46, 256
    s_mov_b32 s47, 0x00020000
    s_cmp_eq_u32 s5, 4
    s_cbranch_scc1 L_D2_ctl
    s_cmp_eq_u32 s5, 5
    s_cbranch_scc1 L_D2_flag
    v_lshrrev_b32 v245, 2, v1
    v_mul_u32_u24 v245, 3584, v245
    v_and_b32 v246, 3, v1
    v_and_b32 v247, 1, v3
    v_xor_b32 v246, v246, v247
    v_lshl_add_u32 v244, v246, 4, v245
    v_xor_b32 v246, 2, v246
    v_lshl_add_u32 v245, v246, 4, v245
    s_sub_u32 s48, s5, 6
    s_lshl_b32 s49, s48, 14
    s_add_u32 m0, s49, 65536
    s_mul_i32 s49, s48, 917504
    s_cmp_lg_u32 s5, 6
    s_cbranch_scc1 L_D2_wm0
L_D2_wm0:
    s_cmp_lg_u32 s5, 7
    s_cbranch_scc1 L_D2_wm1
L_D2_wm1:
    s_barrier
    buffer_load_dwordx4 v244, s[40:43], s49 offen lds
    s_add_u32 m0, m0, 1024
    s_add_u32 s49, s49, 57344
    buffer_load_dwordx4 v244, s[40:43], s49 offen lds
    s_add_u32 m0, m0, 1024
    s_add_u32 s49, s49, 57344
    buffer_load_dwordx4 v244, s[40:43], s49 offen lds
    s_add_u32 m0, m0, 1024
    s_add_u32 s49, s49, 57344
    buffer_load_dwordx4 v244, s[40:43], s49 offen lds
    s_add_u32 m0, m0, 1024
    s_add_u32 s49, s49, 57344
    buffer_load_dwordx4 v245, s[40:43], s49 offen lds
    s_add_u32 m0, m0, 1024
    s_add_u32 s49, s49, 57344
    buffer_load_dwordx4 v245, s[40:43], s49 offen lds
    s_add_u32 m0, m0, 1024
    s_add_u32 s49, s49, 57344
    buffer_load_dwordx4 v245, s[40:43], s49 offen lds
    s_add_u32 m0, m0, 1024
    s_add_u32 s49, s49, 57344
    buffer_load_dwordx4 v245, s[40:43], s49 offen lds
    s_add_u32 m0, m0, 1024
    s_add_u32 s49, s49, 57344
    buffer_load_dwordx4 v244, s[40:43], s49 offen lds
    s_add_u32 m0, m0, 1024
    s_add_u32 s49, s49, 57344
    buffer_load_dwordx4 v244, s[40:43], s49 offen lds
    s_add_u32 m0, m0, 1024
    s_add_u32 s49, s49, 57344
    buffer_load_dwordx4 v244, s[40:43], s49 offen lds
    s_add_u32 m0, m0, 1024
    s_add_u32 s49, s49, 57344
    buffer_load_dwordx4 v244, s[40:43], s49 offen lds
    s_add_u32 m0, m0, 1024
    s_add_u32 s49, s49, 57344
    buffer_load_dwordx4 v245, s[40:43], s49 offen lds
    s_add_u32 m0, m0, 1024
    s_add_u32 s49, s49, 57344
    buffer_load_dwordx4 v245, s[40:43], s49 offen lds
    s_add_u32 m0, m0, 1024
    s_add_u32 s49, s49, 57344
    buffer_load_dwordx4 v245, s[40:43], s49 offen lds
    s_add_u32 m0, m0, 1024
    s_add_u32 s49, s49, 57344
    buffer_load_dwordx4 v245, s[40:43], s49 offen lds
    s_waitcnt vmcnt(0)
    s_barrier
    s_endpgm
L_D2_flag:
    s_lshl_b32 s49, s3, 5
    s_lshl_b32 s50, s6, 2
    s_add_u32 s49, s49, s50
    v_mov_b32 v224, 1
    v_mov_b32 v225, s49
    v_lshlrev_b32 v226, 2, v1
    s_waitcnt vmcnt(0)
    s_mov_b64 exec, 1
    buffer_store_dword v224, v225, s[44:47], 0 offen sc1
    s_mov_b64 exec, -1
    s_barrier
    s_waitcnt vmcnt(0)
L_D2_fpoll:
    buffer_load_dword v227, v226, s[44:47], 0 offen sc1
    s_waitcnt vmcnt(0)
    v_cmp_ne_u32 vcc, 1, v227
    s_cbranch_vccz L_D2_fok
    s_sleep 8
    s_sub_u32 s57, s57, 1
    s_cbranch_scc1 L_exit
    s_branch L_D2_fpoll
L_D2_fok:
    s_barrier
    s_endpgm
L_D2_ctl:
    s_waitcnt vmcnt(0)
    v_readfirstlane_b32 s72, v241
    v_mov_b32 v212, -1
    v_mov_b32 v213, -1
    v_mov_b32 v214, -1
    v_mov_b32 v215, -1
    s_add_u32 s72, s72, 1
    s_getreg_b32 s73, hwreg(HW_REG_XCC_ID, 0, 4)
    v_mov_b32 v209, s72
    s_lshl_b32 s51, s4, 3
    v_mov_b32 v208, s73
    v_mov_b32 v210, s51
    s_mov_b64 exec, 1
    buffer_store_dwordx2 v[208:209], v210, s[32:35], s74 offen offset:2048
    s_mov_b64 exec, -1
    s_sub_u32 s81, s57, 160
    v_and_b32 v211, 31, v1
    v_lshlrev_b32 v211, 3, v211
    s_not_b32 s49, s72
    v_mov_b32 v221, s49
L_d2x_poll:
    buffer_load_dwordx2 v[220:221], v211, s[32:35], s74 offen offset:2048 sc1
    s_waitcnt vmcnt(6)
    v_cmp_ne_u32 vcc, s72, v221
    s_cbranch_vccz L_d2x_seen
    s_sleep 3
    s_cmp_gt_u32 s57, s81
    s_cbranch_scc0 L_d2x_b
    s_sub_u32 s57, s57, 1
    s_cbranch_scc1 L_exit
    s_branch L_d2x_poll
L_d2x_seen:
    s_nop 15
L_d2x_ok:
    v_cmp_ne_u32 vcc, s73, v220
    s_nop 3
    s_cmp_eq_u64 vcc, 0
    s_cselect_b32 s92, 1, 0
    s_cbranch_scc0 L_d2x_slow
L_d2x_done:
    v_mov_b32 v226, 141312
    v_mov_b32 v227, s92
    ds_write_b32 v226, v227
    s_waitcnt lgkmcnt(0)
    s_barrier
    s_barrier
    s_endpgm
L_aq0_b:
    s_mov_b64 exec, 1
    buffer_store_dwordx2 v[208:209], v210, s[32:35], s75 offen offset:2048 sc1
    s_mov_b64 exec, -1
L_aq0_alt:
    buffer_load_dwordx4 v[212:215], v232, s[32:35], s75 offen sc1
    buffer_load_dwordx4 v[216:219], v232, s[32:35], s75 offen offset:1024 sc1
    buffer_load_dwordx2 v[220:221], v211, s[32:35], s75 offen offset:2048 sc1
    s_waitcnt vmcnt(0)
    v_xor_b32 v224, s72, v213
    v_xor_b32 v225, s72, v215
    v_xor_b32 v226, s72, v217
    v_xor_b32 v227, s72, v219
    v_or3_b32 v224, v224, v225, v226
    v_or_b32 v224, v224, v227
    v_cmp_ne_u32 vcc, 0, v224
    s_cbranch_vccz L_aq0_altok
    buffer_load_dwordx4 v[212:215], v232, s[32:35], s74 offen sc1
    buffer_load_dwordx4 v[216:219], v232, s[32:35], s74 offen offset:1024 sc1
    buffer_load_dwordx2 v[220:221], v211, s[32:35], s74 offen offset:2048 sc1
    s_waitcnt vmcnt(0)
    v_xor_b32 v224, s72, v213
    v_xor_b32 v225, s72, v215
    v_xor_b32 v226, s72, v217
    v_xor_b32 v227, s72, v219
    v_or3_b32 v224, v224, v225, v226
    v_or_b32 v224, v224, v227
    v_cmp_ne_u32 vcc, 0, v224
    s_cbranch_vccz L_aq0_altok
    s_sub_u32 s57, s57, 1
    s_cbranch_scc1 L_exit
    s_branch L_aq0_alt
L_aq0_altok:
    s_not_b32 s49, s72
    v_mov_b32 v221, s49
    s_branch L_aq0_ok
L_ax_b:
    s_mov_b64 exec, 1
    buffer_store_dwordx2 v[208:209], v210, s[32:35], s75 offen offset:2048 sc1
    s_mov_b64 exec, -1
L_ax_alt:
    buffer_load_dwordx2 v[220:221], v211, s[32:35], s75 offen offset:2048 sc1
    s_waitcnt vmcnt(0)
    v_cmp_ne_u32 vcc, s72, v221
    s_cbranch_vccz L_ax_ok
    buffer_load_dwordx2 v[220:221], v211, s[32:35], s74 offen offset:2048 sc1
    s_waitcnt vmcnt(0)
    v_cmp_ne_u32 vcc, s72, v221
    s_cbranch_vccz L_ax_ok
    s_sub_u32 s57, s57, 1
    s_cbranch_scc1 L_exit
    s_branch L_ax_alt
L_ax_slow:
    s_waitcnt vmcnt(0) lgkmcnt(0)
    s_mov_b64 exec, 1
    buffer_store_dwordx2 v[208:209], v210, s[32:35], s75 offen offset:2048 sc1
    s_mov_b64 exec, -1
    v_and_b32 v211, 56, v211
    v_add_u32 v211, 192, v211
L_ax_h:
    buffer_load_dwordx2 v[220:221], v211, s[32:35], s75 offen offset:2560 sc1
    s_waitcnt vmcnt(0)
    v_cmp_ne_u32 vcc, s72, v221
    s_cbranch_vccz L_ax_done
    s_sub_u32 s57, s57, 1
    s_cbranch_scc1 L_exit
    s_branch L_ax_h
L_d1x_b:
    s_mov_b64 exec, 1
    buffer_store_dwordx2 v[208:209], v210, s[32:35], s75 offen offset:2048 sc1
    s_mov_b64 exec, -1
L_d1x_alt:
    buffer_load_dwordx2 v[220:221], v211, s[32:35], s75 offen offset:2048 sc1
    s_waitcnt vmcnt(0)
    v_cmp_ne_u32 vcc, s72, v221
    s_cbranch_vccz L_d1x_ok
    buffer_load_dwordx2 v[220:221], v211, s[32:35], s74 offen offset:2048 sc1
    s_waitcnt vmcnt(0)
    v_cmp_ne_u32 vcc, s72, v221
    s_cbranch_vccz L_d1x_ok
    s_sub_u32 s57, s57, 1
    s_cbranch_scc1 L_exit
    s_branch L_d1x_alt
L_d1x_slow:
    s_waitcnt vmcnt(0) lgkmcnt(0)
    s_mov_b64 exec, 1
    buffer_store_dwordx2 v[208:209], v210, s[32:35], s75 offen offset:2048 sc1
    s_mov_b64 exec, -1
    v_and_b32 v211, 56, v211
    v_add_u32 v211, 192, v211
L_d1x_h:
    buffer_load_dwordx2 v[220:221], v211, s[32:35], s75 offen offset:2560 sc1
    s_waitcnt vmcnt(0)
    v_cmp_ne_u32 vcc, s72, v221
    s_cbranch_vccz L_d1x_done
    s_sub_u32 s57, s57, 1
    s_cbranch_scc1 L_exit
    s_branch L_d1x_h
L_d2x_b:
    s_mov_b64 exec, 1
    buffer_store_dwordx2 v[208:209], v210, s[32:35], s75 offen offset:2048 sc1
    s_mov_b64 exec, -1
L_d2x_alt:
    buffer_load_dwordx2 v[220:221], v211, s[32:35], s75 offen offset:2048 sc1
    s_waitcnt vmcnt(0)
    v_cmp_ne_u32 vcc, s72, v221
    s_cbranch_vccz L_d2x_ok
    buffer_load_dwordx2 v[220:221], v211, s[32:35], s74 offen offset:2048 sc1
    s_waitcnt vmcnt(0)
    v_cmp_ne_u32 vcc, s72, v221
    s_cbranch_vccz L_d2x_ok
    s_sub_u32 s57, s57, 1
    s_cbranch_scc1 L_exit
    s_branch L_d2x_alt
L_d2x_slow:
    s_waitcnt vmcnt(0) lgkmcnt(0)
    s_mov_b64 exec, 1
    buffer_store_dwordx2 v[208:209], v210, s[32:35], s75 offen offset:2048 sc1
    s_mov_b64 exec, -1
    v_mov_b32 v212, -1
    v_mov_b32 v213, -1
    v_mov_b32 v214, -1
    v_mov_b32 v215, -1
    s_lshl_b32 s49, s6, 11
    s_add_u32 s49, s49, s56
    s_add_u32 s49, s49, 524288
    s_add_u32 s50, s49, 196608
    buffer_store_dwordx4 v[212:215], v232, s[32:35], s49 offen offset:0 sc1
    buffer_store_dwordx4 v[212:215], v232, s[32:35], s49 offen offset:1024 sc1
    buffer_store_dwordx4 v[212:215], v232, s[32:35], s50 offen offset:0 sc1
    buffer_store_dwordx4 v[212:215], v232, s[32:35], s50 offen offset:1024 sc1
    s_mov_b32 s49, 196608
    v_lshrrev_b32 v224, 5, v1
    v_mul_lo_u32 v224, v224, s49
    v_and_b32 v225, 31, v1
    v_lshl_add_u32 v224, v225, 4, v224
    s_lshl_b32 s49, s6, 9
    s_add_u32 s49, s49, s52
    s_add_u32 s49, s49, 524288
    buffer_store_dwordx4 v[212:215], v224, s[32:35], s49 offen sc1
    s_waitcnt vmcnt(0)
    s_mov_b64 exec, 1
    buffer_store_dwordx2 v[208:209], v210, s[32:35], s75 offen offset:2560 sc1
    s_mov_b64 exec, -1
    v_and_b32 v211, 56, v211
    v_add_u32 v211, 192, v211
L_d2x_h:
    buffer_load_dwordx2 v[220:221], v211, s[32:35], s75 offen offset:2560 sc1
    s_waitcnt vmcnt(0)
    v_cmp_ne_u32 vcc, s72, v221
    s_cbranch_vccz L_d2x_done
    s_sub_u32 s57, s57, 1
    s_cbranch_scc1 L_exit
    s_branch L_d2x_h
L_exit:
    s_endpgm
L_gp_retry:
    v_pk_max_u16 v160, v64, v65
    v_pk_max_u16 v161, v66, v67
    v_pk_max_u16 v162, v68, v69
    v_pk_max_u16 v163, v70, v71
    v_pk_max_u16 v164, v72, v73
    v_pk_max_u16 v165, v74, v75
    v_pk_max_u16 v166, v76, v77
    v_pk_max_u16 v167, v78, v79
    v_pk_max_u16 v160, v160, v161
    v_pk_max_u16 v161, v162, v163
    v_pk_max_u16 v162, v164, v165
    v_pk_max_u16 v163, v166, v167
    v_pk_max_u16 v49, v160, v161
    v_pk_max_u16 v50, v162, v163
    v_pk_max_u16 v49, v49, v50
    v_pk_max_u16 v49, v49, v49 op_sel:[0,1] op_sel_hi:[1,0]
    v_cmp_eq_u32 vcc, -1, v49
    s_cbranch_vccnz L_gp_again
    v_mfma_f32_16x16x32_bf16 v[232:235], v[80:83], v[64:67], 0
    v_mfma_f32_16x16x32_bf16 v[232:235], v[84:87], v[68:71], v[232:235]
    v_mfma_f32_16x16x32_bf16 v[232:235], v[88:91], v[72:75], v[232:235]
    v_mfma_f32_16x16x32_bf16 v[232:235], v[92:95], v[76:79], v[232:235]
    s_nop 9
    v_permlane32_swap_b32 v232, v234
    v_permlane32_swap_b32 v233, v235
    s_branch L_gp_ok
L_gz_retry:
    v_pk_max_u16 v160, v64, v65
    v_pk_max_u16 v161, v66, v67
    v_pk_max_u16 v162, v68, v69
    v_pk_max_u16 v163, v70, v71
    v_pk_max_u16 v164, v72, v73
    v_pk_max_u16 v165, v74, v75
    v_pk_max_u16 v166, v76, v77
    v_pk_max_u16 v167, v78, v79
    v_pk_max_u16 v168, v80, v81
    v_pk_max_u16 v169, v82, v83
    v_pk_max_u16 v170, v84, v85
    v_pk_max_u16 v171, v86, v87
    v_pk_max_u16 v172, v88, v89
    v_pk_max_u16 v173, v90, v91
    v_pk_max_u16 v174, v92, v93
    v_pk_max_u16 v175, v94, v95
    v_pk_max_u16 v160, v160, v161
    v_pk_max_u16 v161, v162, v163
    v_pk_max_u16 v162, v164, v165
    v_pk_max_u16 v163, v166, v167
    v_pk_max_u16 v164, v168, v169
    v_pk_max_u16 v165, v170, v171
    v_pk_max_u16 v166, v172, v173
    v_pk_max_u16 v167, v174, v175
    v_pk_max_u16 v160, v160, v161
    v_pk_max_u16 v161, v162, v163
    v_pk_max_u16 v162, v164, v165
    v_pk_max_u16 v163, v166, v167
    v_pk_max_u16 v49, v160, v161
    v_pk_max_u16 v50, v162, v163
    v_pk_max_u16 v49, v49, v50
    v_pk_max_u16 v49, v49, v49 op_sel:[0,1] op_sel_hi:[1,0]
    v_cmp_eq_u32 vcc, -1, v49
    s_cbranch_vccnz L_gz_again
    v_mfma_f32_16x16x32_bf16 v[36:39], v[16:19], v[64:67], v[28:31]
    v_mfma_f32_16x16x32_bf16 v[36:39], v[20:23], v[68:71], v[36:39]
    v_mfma_f32_16x16x32_bf16 v[40:43], v[16:19], v[72:75], v[32:35]
    v_mfma_f32_16x16x32_bf16 v[40:43], v[20:23], v[76:79], v[40:43]
    v_mfma_f32_16x16x32_bf16 v[36:39], v[16:19], v[80:83], v[36:39]
    v_mfma_f32_16x16x32_bf16 v[36:39], v[20:23], v[84:87], v[36:39]
    v_mfma_f32_16x16x32_bf16 v[40:43], v[16:19], v[88:91], v[40:43]
    v_mfma_f32_16x16x32_bf16 v[40:43], v[20:23], v[92:95], v[40:43]
    s_nop 7
    v_cvt_pk_bf16_f32 v44, v36, v37
    v_cvt_pk_bf16_f32 v45, v38, v39
    v_cvt_pk_bf16_f32 v46, v40, v41
    v_cvt_pk_bf16_f32 v47, v42, v43
    s_branch L_gz_ok
L_gy_retry:
    v_pk_max_u16 v160, v64, v65
    v_pk_max_u16 v161, v66, v67
    v_pk_max_u16 v162, v68, v69
    v_pk_max_u16 v163, v70, v71
    v_pk_max_u16 v164, v72, v73
    v_pk_max_u16 v165, v74, v75
    v_pk_max_u16 v166, v76, v77
    v_pk_max_u16 v167, v78, v79
    v_pk_max_u16 v168, v80, v81
    v_pk_max_u16 v169, v82, v83
    v_pk_max_u16 v170, v84, v85
    v_pk_max_u16 v171, v86, v87
    v_pk_max_u16 v172, v88, v89
    v_pk_max_u16 v173, v90, v91
    v_pk_max_u16 v174, v92, v93
    v_pk_max_u16 v175, v94, v95
    v_pk_max_u16 v160, v160, v161
    v_pk_max_u16 v161, v162, v163
    v_pk_max_u16 v162, v164, v165
    v_pk_max_u16 v163, v166, v167
    v_pk_max_u16 v164, v168, v169
    v_pk_max_u16 v165, v170, v171
    v_pk_max_u16 v166, v172, v173
    v_pk_max_u16 v167, v174, v175
    v_pk_max_u16 v160, v160, v161
    v_pk_max_u16 v161, v162, v163
    v_pk_max_u16 v162, v164, v165
    v_pk_max_u16 v163, v166, v167
    v_pk_max_u16 v49, v160, v161
    v_pk_max_u16 v50, v162, v163
    v_pk_max_u16 v49, v49, v50
    v_pk_max_u16 v49, v49, v49 op_sel:[0,1] op_sel_hi:[1,0]
    v_cmp_eq_u32 vcc, -1, v49
    s_cbranch_vccnz L_gy_again
    v_mfma_f32_16x16x32_bf16 v[36:39], v[16:19], v[64:67], v[28:31]
    v_mfma_f32_16x16x32_bf16 v[36:39], v[20:23], v[68:71], v[36:39]
    v_mfma_f32_16x16x32_bf16 v[40:43], v[16:19], v[72:75], v[32:35]
    v_mfma_f32_16x16x32_bf16 v[40:43], v[20:23], v[76:79], v[40:43]
    v_mfma_f32_16x16x32_bf16 v[36:39], v[16:19], v[80:83], v[36:39]
    v_mfma_f32_16x16x32_bf16 v[36:39], v[20:23], v[84:87], v[36:39]
    v_mfma_f32_16x16x32_bf16 v[40:43], v[16:19], v[88:91], v[40:43]
    v_mfma_f32_16x16x32_bf16 v[40:43], v[20:23], v[92:95], v[40:43]
    s_nop 7
    v_cvt_pk_bf16_f32 v44, v36, v37
    v_cvt_pk_bf16_f32 v45, v38, v39
    v_cvt_pk_bf16_f32 v46, v40, v41
    v_cvt_pk_bf16_f32 v47, v42, v43
    s_branch L_gy_ok
L_code_end:
.section .rodata,"a"
.p2align 6
.amdhsa_kernel interleave_layers__sliding_block_cached__dense_activation_mish__decode_kernel
  .amdhsa_next_free_vgpr 256
  .amdhsa_next_free_sgpr 96
  .amdhsa_accum_offset 256
  .amdhsa_group_segment_fixed_size 0
  .amdhsa_kernarg_size 96
  .amdhsa_user_sgpr_count 2
  .amdhsa_user_sgpr_kernarg_segment_ptr 1
  .amdhsa_system_sgpr_workgroup_id_x 1
  .amdhsa_float_denorm_mode_32 3
.end_amdhsa_kernel
```
